```python
import torch

def _softmax(x, axis=-1):
    return torch.softmax(x, dim=axis)

def _gelu(x):
    return torch.nn.functional.gelu(x, approximate='tanh')

def _silu(x):
    return torch.nn.functional.silu(x)

def _sigmoid(x):
    return torch.sigmoid(x)

def _layernorm(x, axis=-1, eps=1e-05):
    m = x.mean(dim=axis, keepdim=True)
    v = x.var(dim=axis, keepdim=True, unbiased=False)
    return (x - m) / torch.sqrt(v + eps)

def _scatter_add(tgt, idx, src, axis=0):
    return tgt.clone().index_add_(axis, idx, src)

def _segment_sum(src, seg, n):
    out = torch.zeros((n,) + src.shape[1:], dtype=src.dtype)
    return out.index_add_(0, seg, src)

def _pad(x, pw):
    flat = tuple((v for pair in reversed(pw) for v in pair))
    return torch.nn.functional.pad(x, flat)
kernel_name = 'parallel_sum__softmax_full_mha__mixer_gmlp__prompt'

def setup_inputs():

    _w = lambda a: (lambda t: t.to(torch.bfloat16) if t.is_floating_point() else t)(torch.as_tensor(a))

    def _A_setup():
        B, S, D = (1, 2048, 640)
        return {'x': _w((lambda *s: torch.randn(*s, dtype=torch.bfloat16) * 0.05)(B, S, D)), 'wqkv': _w((lambda *s: torch.randn(*s, dtype=torch.bfloat16) * 0.2)(D, 3 * D)), 'wo': _w((lambda *s: torch.randn(*s, dtype=torch.bfloat16) * 0.1)(D, D))}
    _A_in = _A_setup()

    def _B_setup():
        B, S, D, F = (1, 2048, 640, 1536)
        Fh = F // 2
        return {'x': _w((lambda *s: torch.randn(*s, dtype=torch.bfloat16) * 0.05)(B, S, D)), 'w_in': _w((lambda *s: torch.randn(*s, dtype=torch.bfloat16) * 0.8)(D, 2 * Fh)), 'w_sp': _w(0.01 * (lambda *s: torch.randn(*s, dtype=torch.bfloat16) * 0.8)(S, S)), 'b_sp': _w(1.0 + 0.01 * (lambda *s: torch.randn(*s, dtype=torch.bfloat16) * 0.2)(S)), 'w_out': _w((lambda *s: torch.randn(*s, dtype=torch.bfloat16) * 0.2)(Fh, D))}
    _B_in = _B_setup()
    return {'A_x': _A_in['x'], 'A_wqkv': _A_in['wqkv'], 'A_wo': _A_in['wo'], 'B_x': _B_in['x'], 'B_w_in': _B_in['w_in'], 'B_w_sp': _B_in['w_sp'], 'B_b_sp': _B_in['b_sp'], 'B_w_out': _B_in['w_out']}

def reference(A_x, A_wqkv, A_wo, B_x, B_w_in, B_w_sp, B_b_sp, B_w_out):

    def _A_ref(x, wqkv, wo):
        B, S, D = x.shape
        H = 32
        Dh = D // H
        qkv = (lambda x, *d: x.permute(*d))((x @ wqkv).reshape(B, S, 3, H, Dh), 2, 0, 3, 1, 4)
        q, k, v = (qkv[0], qkv[1], qkv[2])
        scale = Dh ** (-0.5)
        scores = torch.einsum('bhqd,bhkd->bhqk', q, k) * scale
        p = _softmax(scores, axis=-1)
        o = torch.einsum('bhqk,bhkd->bhqd', p, v)
        return (lambda x, *d: x.permute(*d))(o, 0, 2, 1, 3).reshape(B, S, D) @ wo

    def _B_ref(x, w_in, w_sp, b_sp, w_out):
        B, S, D = x.shape
        F = w_in.shape[-1]
        Fh = F // 2
        z = _gelu(torch.einsum('bsd,df->bsf', x, w_in))
        z1 = z[..., :Fh].clone()
        z2 = _layernorm(z[..., Fh:], axis=-1)
        g = torch.einsum('ts,bsf->btf', w_sp, z2) + b_sp[None, :, None]
        return torch.einsum('bsf,fd->bsd', z1 * g, w_out)
    x = A_x
    xn = _layernorm(x, axis=-1)
    return x + _A_ref(xn, A_wqkv, A_wo) + _B_ref(xn, B_w_in, B_w_sp, B_b_sp, B_w_out)
```

```asm
; @launch grid=(256,1,1) block=(512,1,1) lds=163840
.amdgcn_target "amdgcn-amd-amdhsa--gfx950"
.text
.globl parallel_sum__softmax_full_mha__mixer_gmlp__prompt_kernel
.p2align 8
.type parallel_sum__softmax_full_mha__mixer_gmlp__prompt_kernel,@function
parallel_sum__softmax_full_mha__mixer_gmlp__prompt_kernel:
    s_cmp_ge_u32 s2, 256
    s_cbranch_scc1 K2_exit
    s_load_dwordx2 s[62:63], s[0:1], 0
    s_load_dwordx2 s[6:7], s[0:1], 8
    s_load_dwordx2 s[10:11], s[0:1], 80
    s_load_dwordx2 s[100:101], s[0:1], 72
    s_load_dwordx2 s[98:99], s[0:1], 32
    s_load_dwordx2 s[4:5], s[0:1], 16
    s_load_dwordx4 s[44:47], s[0:1], 40
    s_load_dwordx2 s[8:9], s[0:1], 56
    s_load_dwordx2 s[74:75], s[0:1], 64
    v_lshrrev_b32 v1, 6, v0
    v_and_b32 v2, 63, v0
    v_readfirstlane_b32 s12, v1
    s_bfe_u32 s14, s2, 0x30003
    s_and_b32 s15, s2, 1
    s_lshl_b32 s35, s15, 3
    s_add_u32 s35, s35, s14
    s_bfe_u32 s36, s2, 0x20001
    s_lshl_b32 s36, s36, 2
    s_lshr_b32 s15, s2, 6
    s_add_u32 s36, s36, s15
    s_and_b32 s13, s2, 7
    s_lshl_b32 s13, s13, 2
    s_lshr_b32 s15, s2, 6
    s_add_u32 s13, s13, s15
    s_and_b32 s32, s13, 1
    s_lshr_b32 s33, s13, 1
    s_mul_i32 s33, s33, 5
    s_mul_i32 s34, s32, 3
    s_add_u32 s34, s34, s33
    s_add_u32 s33, s33, 2
    v_and_b32 v3, 31, v2
    v_lshrrev_b32 v4, 5, v2
    s_cmp_ge_u32 s12, 4
    s_cbranch_scc1 K2_G
    s_getpc_b64 s[58:59]
ct_1:
    s_add_u32 s58, s58, P1C_go-ct_1
    s_addc_u32 s59, s59, 0
    s_lshl_b32 s15, s12, 13
    v_lshl_add_u32 v5, v2, 7, s15
    v_min_u32 v5, CODE_END-P1C_go-4, v5
    global_load_dword v11, v5, s[58:59]
    s_add_u32 s15, s15, 0x8000
    v_lshl_add_u32 v5, v2, 7, s15
    v_min_u32 v5, CODE_END-P1C_go-4, v5
    global_load_dword v11, v5, s[58:59]
P1C_go:
    s_lshr_b32 s37, s12, 1
    s_and_b32 s38, s12, 1
    v_bfe_u32 v5, v2, 2, 2
    v_and_b32 v6, 3, v2
    v_lshlrev_b32 v6, 3, v6
    v_bfe_u32 v7, v2, 4, 1
    v_lshl_add_u32 v8, v4, 3, v5
    v_lshlrev_b32 v8, 8, v8
    v_add_u32 v8, 81920, v8
    s_lshl_b32 s39, s12, 12
    s_lshl_b32 s15, s38, 1
    v_bfe_u32 v9, v2, 1, 3
    v_xor_b32 v9, v9, v4
    v_xor_b32 v9, s15, v9
    v_lshl_add_u32 v10, v3, 7, s39
    v_xor_b32 v13, 0, v9
    v_lshl_add_u32 v16, v13, 4, v10
    v_add_u32 v20, 0x10000, v16
    v_xor_b32 v13, 2, v9
    v_lshl_add_u32 v17, v13, 4, v10
    v_add_u32 v21, 0x10000, v17
    v_xor_b32 v13, 4, v9
    v_lshl_add_u32 v18, v13, 4, v10
    v_add_u32 v22, 0x10000, v18
    v_xor_b32 v13, 6, v9
    v_lshl_add_u32 v19, v13, 4, v10
    v_add_u32 v23, 0x10000, v19
    s_lshl_b32 s39, s38, 12
    s_mul_i32 s53, s36, 96
    s_and_b32 s53, s53, 63
    v_lshl_add_u32 v9, v7, 5, v6
    s_add_u32 s15, s53, 0
    v_add_u32 v9, s15, v9
    v_lshrrev_b32 v10, 2, v9
    v_and_b32 v10, 32, v10
    v_xor_b32 v9, v9, v10
    v_lshrrev_b32 v10, 6, v9
    v_xor_b32 v10, v10, v5
    v_and_b32 v9, 63, v9
    v_lshl_add_u32 v9, v10, 6, v9
    v_add_u32 v9, v9, v8
    v_add_u32 v24, s39, v9
    v_subrev_u32 v27, s39, v9
    v_lshl_add_u32 v9, v7, 6, v6
    s_add_u32 s15, s53, 64
    v_add_u32 v9, s15, v9
    v_lshrrev_b32 v10, 2, v9
    v_and_b32 v10, 32, v10
    v_xor_b32 v9, v9, v10
    v_lshrrev_b32 v10, 6, v9
    v_xor_b32 v10, v10, v5
    v_and_b32 v9, 63, v9
    v_lshl_add_u32 v9, v10, 6, v9
    v_add_u32 v9, v9, v8
    v_add_u32 v25, s39, v9
    v_subrev_u32 v28, s39, v9
    v_lshl_add_u32 v9, v7, 5, v6
    s_add_u32 s15, s53, 160
    v_add_u32 v9, s15, v9
    v_lshrrev_b32 v10, 2, v9
    v_and_b32 v10, 32, v10
    v_xor_b32 v9, v9, v10
    v_lshrrev_b32 v10, 6, v9
    v_xor_b32 v10, v10, v5
    v_and_b32 v9, 63, v9
    v_lshl_add_u32 v9, v10, 6, v9
    v_add_u32 v9, v9, v8
    v_add_u32 v26, s39, v9
    v_subrev_u32 v29, s39, v9
    s_lshl_b32 s39, s37, 13
    s_lshl_b32 s15, s37, 1
    v_bfe_u32 v9, v2, 1, 3
    v_xor_b32 v9, v9, v4
    v_xor_b32 v9, s15, v9
    v_lshl_add_u32 v10, v3, 7, s39
    v_xor_b32 v13, 0, v9
    v_lshl_add_u32 v32, v13, 4, v10
    v_add_u32 v36, 0x10000, v32
    v_xor_b32 v13, 2, v9
    v_lshl_add_u32 v33, v13, 4, v10
    v_add_u32 v37, 0x10000, v33
    v_xor_b32 v13, 4, v9
    v_lshl_add_u32 v34, v13, 4, v10
    v_add_u32 v38, 0x10000, v34
    v_xor_b32 v13, 6, v9
    v_lshl_add_u32 v35, v13, 4, v10
    v_add_u32 v39, 0x10000, v35
    s_lshl_b32 s39, s37, 12
    s_lshl_b32 s15, s38, 7
    s_add_u32 s15, s15, 0
    v_lshl_add_u32 v9, v7, 5, v6
    v_add_u32 v9, s15, v9
    v_lshrrev_b32 v10, 6, v9
    v_xor_b32 v10, v10, v5
    v_and_b32 v9, 63, v9
    v_lshl_add_u32 v9, v10, 6, v9
    v_add_u32 v9, v9, v8
    v_add_u32 v40, s39, v9
    v_subrev_u32 v42, s39, v9
    s_lshl_b32 s15, s38, 7
    s_add_u32 s15, s15, 64
    v_lshl_add_u32 v9, v7, 5, v6
    v_add_u32 v9, s15, v9
    v_lshrrev_b32 v10, 6, v9
    v_xor_b32 v10, v10, v5
    v_and_b32 v9, 63, v9
    v_lshl_add_u32 v9, v10, 6, v9
    v_add_u32 v9, v9, v8
    v_add_u32 v41, s39, v9
    v_subrev_u32 v43, s39, v9
    v_mov_b32 v10, 0x3f803f80
    v_and_b32 v9, 15, v2
    v_cmp_eq_u32 vcc, v7, v9
    v_mov_b32 v60, 0
    v_mov_b32 v61, 0
    v_mov_b32 v62, 0
    v_mov_b32 v63, 0
    v_mov_b32 v64, 0
    v_mov_b32 v65, 0
    v_mov_b32 v66, 0
    v_mov_b32 v67, 0
    v_mov_b32 v68, 0
    v_mov_b32 v69, 0
    v_mov_b32 v70, 0
    v_mov_b32 v71, 0
    v_mov_b32 v72, 0
    v_mov_b32 v73, 0
    v_mov_b32 v74, 0
    v_mov_b32 v75, 0
    v_mov_b32 v76, 0
    v_mov_b32 v77, 0
    v_mov_b32 v78, 0
    v_mov_b32 v79, 0
    v_cndmask_b32 v44, 0, v10, vcc
    v_mov_b32 v45, v44
    v_mov_b32 v46, v44
    v_mov_b32 v47, v44
    s_lshl_b32 s41, s36, 1
    s_add_u32 s41, s41, s38
    s_lshl_b32 s42, s41, 3
    s_mul_hi_u32 s15, s42, 0x33333334
    s_mul_i32 s15, s15, 5
    s_sub_u32 s15, s42, s15
    s_lshl_b32 s15, s15, 1
    s_lshr_b32 s43, 299300, s15
    s_lshl_b32 s54, s42, 5
    s_lshl_b32 s55, s35, 1
    s_add_u32 s55, s55, s37
    s_add_u32 s54, s54, s55
    s_lshl_b32 s54, s54, 10
    s_cmp_eq_u32 s36, 15
    s_cmov_b32 s54, 0x40000000
    s_lshl_b32 s48, s35, 2
    s_add_u32 s48, s48, s12
    s_mul_i32 s49, s48, 48
    s_mul_i32 s15, s36, 3
    s_add_u32 s49, s49, s15
    s_lshl_b32 s49, s49, 10
    s_add_u32 s49, s49, 8388608
    s_lshl_b32 s56, s35, 11
    s_add_u32 s56, s56, 18350080
    s_lshl_b32 s15, s38, 1
    s_add_u32 s15, s15, s37
    s_lshl_b32 s15, s15, 2
    s_add_u32 s15, s15, 149504
    v_lshl_add_u32 v5, v2, 4, s15
    v_lshlrev_b32 v6, 4, v3
    v_add_u32 v6, 149504, v6
    v_lshlrev_b32 v8, 4, v2
    s_mul_i32 s15, s12, 6144
    s_add_u32 s15, s15, 81920
    v_add_u32 v7, s15, v8
    s_lshl_b32 s15, s37, 10
    v_lshl_add_u32 v14, v3, 4, s15
    s_lshl_b32 s15, s12, 9
    v_lshl_add_u32 v15, v3, 4, s15
    s_lshl_b32 s15, s41, 5
    s_add_u32 s15, s15, s55
    s_lshl_b32 s15, s15, 2
    s_add_u32 s57, s15, 27217920
    s_mov_b32 s60, -1
    s_mov_b32 s61, 0
    s_waitcnt lgkmcnt(0)
    s_mov_b32 s24, s10
    s_and_b32 s25, s11, 0xffff
    s_mov_b32 s26, 33554432
    s_mov_b32 s27, 0x00020000
    s_mov_b32 s28, s100
    s_and_b32 s29, s101, 0xffff
    s_mov_b32 s30, 256
    s_mov_b32 s31, 0x00020000
    s_barrier
    ds_read_b128 v[80:83], v32 offset:0
    ds_read_b64_tr_b16 v[88:89], v40 offset:0
    ds_read_b64_tr_b16 v[90:91], v40 offset:1024
    ds_read_b64_tr_b16 v[92:93], v41 offset:0
    ds_read_b64_tr_b16 v[94:95], v41 offset:1024
    ds_read_b128 v[84:87], v32 offset:4096
    ds_read_b128 v[96:99], v33 offset:0
    ds_read_b64_tr_b16 v[104:105], v42 offset:4096
    ds_read_b64_tr_b16 v[106:107], v42 offset:5120
    ds_read_b64_tr_b16 v[108:109], v43 offset:4096
    ds_read_b64_tr_b16 v[110:111], v43 offset:5120
    ds_read_b128 v[100:103], v33 offset:4096
    s_waitcnt lgkmcnt(6)
    v_mfma_f32_32x32x16_bf16 v[192:207], v[88:91], v[80:83], 0
    ds_read_b128 v[112:115], v34 offset:0
    ds_read_b64_tr_b16 v[120:121], v40 offset:8192
    v_mfma_f32_32x32x16_bf16 v[208:223], v[92:95], v[80:83], 0
    ds_read_b64_tr_b16 v[122:123], v40 offset:9216
    ds_read_b64_tr_b16 v[124:125], v41 offset:8192
    v_mfma_f32_16x16x32_bf16 v[72:75], v[44:47], v[88:91], v[72:75]
    v_mfma_f32_32x32x16_bf16 v[224:239], v[88:91], v[84:87], 0
    ds_read_b64_tr_b16 v[126:127], v41 offset:9216
    ds_read_b128 v[116:119], v34 offset:4096
    v_mfma_f32_32x32x16_bf16 v[240:255], v[92:95], v[84:87], 0
    v_mfma_f32_16x16x32_bf16 v[76:79], v[44:47], v[92:95], v[76:79]
    s_waitcnt lgkmcnt(6)
    v_mfma_f32_32x32x16_bf16 v[192:207], v[104:107], v[96:99], v[192:207]
    ds_read_b128 v[128:131], v35 offset:0
    ds_read_b64_tr_b16 v[136:137], v42 offset:12288
    v_mfma_f32_32x32x16_bf16 v[208:223], v[108:111], v[96:99], v[208:223]
    ds_read_b64_tr_b16 v[138:139], v42 offset:13312
    ds_read_b64_tr_b16 v[140:141], v43 offset:12288
    v_mfma_f32_32x32x16_bf16 v[224:239], v[104:107], v[100:103], v[224:239]
    ds_read_b64_tr_b16 v[142:143], v43 offset:13312
    ds_read_b128 v[132:135], v35 offset:4096
    v_mfma_f32_32x32x16_bf16 v[240:255], v[108:111], v[100:103], v[240:255]
    s_waitcnt lgkmcnt(6)
    v_mfma_f32_32x32x16_bf16 v[192:207], v[120:123], v[112:115], v[192:207]
    v_mfma_f32_16x16x32_bf16 v[72:75], v[44:47], v[120:123], v[72:75]
    v_mfma_f32_16x16x32_bf16 v[76:79], v[44:47], v[124:127], v[76:79]
    s_waitcnt lgkmcnt(0)
    s_barrier
    v_mfma_f32_32x32x16_bf16 v[208:223], v[124:127], v[112:115], v[208:223]
    ds_read_b128 v[80:83], v32 offset:16384
    ds_read_b64_tr_b16 v[88:89], v40 offset:16384
    v_mfma_f32_32x32x16_bf16 v[224:239], v[120:123], v[116:119], v[224:239]
    ds_read_b64_tr_b16 v[90:91], v40 offset:17408
    ds_read_b64_tr_b16 v[92:93], v41 offset:16384
    v_mfma_f32_32x32x16_bf16 v[240:255], v[124:127], v[116:119], v[240:255]
    ds_read_b64_tr_b16 v[94:95], v41 offset:17408
    ds_read_b128 v[84:87], v32 offset:20480
    v_mfma_f32_32x32x16_bf16 v[192:207], v[136:139], v[128:131], v[192:207]
    ds_read_b128 v[96:99], v33 offset:16384
    ds_read_b64_tr_b16 v[104:105], v42 offset:20480
    v_mfma_f32_32x32x16_bf16 v[208:223], v[140:143], v[128:131], v[208:223]
    ds_read_b64_tr_b16 v[106:107], v42 offset:21504
    ds_read_b64_tr_b16 v[108:109], v43 offset:20480
    v_mfma_f32_32x32x16_bf16 v[224:239], v[136:139], v[132:135], v[224:239]
    ds_read_b64_tr_b16 v[110:111], v43 offset:21504
    ds_read_b128 v[100:103], v33 offset:20480
    v_mfma_f32_32x32x16_bf16 v[240:255], v[140:143], v[132:135], v[240:255]
    s_waitcnt lgkmcnt(6)
    v_mfma_f32_32x32x16_bf16 v[192:207], v[88:91], v[80:83], v[192:207]
    ds_read_b128 v[112:115], v34 offset:16384
    ds_read_b64_tr_b16 v[120:121], v40 offset:24576
    v_mfma_f32_32x32x16_bf16 v[208:223], v[92:95], v[80:83], v[208:223]
    ds_read_b64_tr_b16 v[122:123], v40 offset:25600
    ds_read_b64_tr_b16 v[124:125], v41 offset:24576
    v_mfma_f32_16x16x32_bf16 v[72:75], v[44:47], v[88:91], v[72:75]
    v_mfma_f32_32x32x16_bf16 v[224:239], v[88:91], v[84:87], v[224:239]
    ds_read_b64_tr_b16 v[126:127], v41 offset:25600
    ds_read_b128 v[116:119], v34 offset:20480
    v_mfma_f32_32x32x16_bf16 v[240:255], v[92:95], v[84:87], v[240:255]
    v_mfma_f32_16x16x32_bf16 v[76:79], v[44:47], v[92:95], v[76:79]
    s_waitcnt lgkmcnt(6)
    v_mfma_f32_32x32x16_bf16 v[192:207], v[104:107], v[96:99], v[192:207]
    ds_read_b128 v[128:131], v35 offset:16384
    ds_read_b64_tr_b16 v[136:137], v42 offset:28672
    v_mfma_f32_32x32x16_bf16 v[208:223], v[108:111], v[96:99], v[208:223]
    ds_read_b64_tr_b16 v[138:139], v42 offset:29696
    ds_read_b64_tr_b16 v[140:141], v43 offset:28672
    v_mfma_f32_32x32x16_bf16 v[224:239], v[104:107], v[100:103], v[224:239]
    ds_read_b64_tr_b16 v[142:143], v43 offset:29696
    ds_read_b128 v[132:135], v35 offset:20480
    v_mfma_f32_32x32x16_bf16 v[240:255], v[108:111], v[100:103], v[240:255]
    s_waitcnt lgkmcnt(6)
    v_mfma_f32_32x32x16_bf16 v[192:207], v[120:123], v[112:115], v[192:207]
    v_mfma_f32_16x16x32_bf16 v[72:75], v[44:47], v[120:123], v[72:75]
    v_mfma_f32_16x16x32_bf16 v[76:79], v[44:47], v[124:127], v[76:79]
    s_waitcnt lgkmcnt(0)
    s_barrier
    v_mfma_f32_32x32x16_bf16 v[208:223], v[124:127], v[112:115], v[208:223]
    ds_read_b128 v[80:83], v32 offset:32768
    ds_read_b64_tr_b16 v[88:89], v40 offset:32768
    v_mfma_f32_32x32x16_bf16 v[224:239], v[120:123], v[116:119], v[224:239]
    ds_read_b64_tr_b16 v[90:91], v40 offset:33792
    ds_read_b64_tr_b16 v[92:93], v41 offset:32768
    v_mfma_f32_32x32x16_bf16 v[240:255], v[124:127], v[116:119], v[240:255]
    ds_read_b64_tr_b16 v[94:95], v41 offset:33792
    ds_read_b128 v[84:87], v32 offset:36864
    v_mfma_f32_32x32x16_bf16 v[192:207], v[136:139], v[128:131], v[192:207]
    ds_read_b128 v[96:99], v33 offset:32768
    ds_read_b64_tr_b16 v[104:105], v42 offset:36864
    v_mfma_f32_32x32x16_bf16 v[208:223], v[140:143], v[128:131], v[208:223]
    ds_read_b64_tr_b16 v[106:107], v42 offset:37888
    ds_read_b64_tr_b16 v[108:109], v43 offset:36864
    v_mfma_f32_32x32x16_bf16 v[224:239], v[136:139], v[132:135], v[224:239]
    ds_read_b64_tr_b16 v[110:111], v43 offset:37888
    ds_read_b128 v[100:103], v33 offset:36864
    v_mfma_f32_32x32x16_bf16 v[240:255], v[140:143], v[132:135], v[240:255]
    s_waitcnt lgkmcnt(6)
    v_mfma_f32_32x32x16_bf16 v[192:207], v[88:91], v[80:83], v[192:207]
    ds_read_b128 v[112:115], v34 offset:32768
    ds_read_b64_tr_b16 v[120:121], v40 offset:40960
    v_mfma_f32_32x32x16_bf16 v[208:223], v[92:95], v[80:83], v[208:223]
    ds_read_b64_tr_b16 v[122:123], v40 offset:41984
    ds_read_b64_tr_b16 v[124:125], v41 offset:40960
    v_mfma_f32_16x16x32_bf16 v[72:75], v[44:47], v[88:91], v[72:75]
    v_mfma_f32_32x32x16_bf16 v[224:239], v[88:91], v[84:87], v[224:239]
    ds_read_b64_tr_b16 v[126:127], v41 offset:41984
    ds_read_b128 v[116:119], v34 offset:36864
    v_mfma_f32_32x32x16_bf16 v[240:255], v[92:95], v[84:87], v[240:255]
    v_mfma_f32_16x16x32_bf16 v[76:79], v[44:47], v[92:95], v[76:79]
    s_waitcnt lgkmcnt(6)
    v_mfma_f32_32x32x16_bf16 v[192:207], v[104:107], v[96:99], v[192:207]
    ds_read_b128 v[128:131], v35 offset:32768
    ds_read_b64_tr_b16 v[136:137], v42 offset:45056
    v_mfma_f32_32x32x16_bf16 v[208:223], v[108:111], v[96:99], v[208:223]
    ds_read_b64_tr_b16 v[138:139], v42 offset:46080
    ds_read_b64_tr_b16 v[140:141], v43 offset:45056
    v_mfma_f32_32x32x16_bf16 v[224:239], v[104:107], v[100:103], v[224:239]
    ds_read_b64_tr_b16 v[142:143], v43 offset:46080
    ds_read_b128 v[132:135], v35 offset:36864
    v_mfma_f32_32x32x16_bf16 v[240:255], v[108:111], v[100:103], v[240:255]
    s_waitcnt lgkmcnt(6)
    v_mfma_f32_32x32x16_bf16 v[192:207], v[120:123], v[112:115], v[192:207]
    v_mfma_f32_16x16x32_bf16 v[72:75], v[44:47], v[120:123], v[72:75]
    v_mfma_f32_16x16x32_bf16 v[76:79], v[44:47], v[124:127], v[76:79]
    s_waitcnt lgkmcnt(0)
    s_barrier
    v_mfma_f32_32x32x16_bf16 v[208:223], v[124:127], v[112:115], v[208:223]
    ds_read_b128 v[80:83], v32 offset:49152
    ds_read_b64_tr_b16 v[88:89], v40 offset:49152
    v_mfma_f32_32x32x16_bf16 v[224:239], v[120:123], v[116:119], v[224:239]
    ds_read_b64_tr_b16 v[90:91], v40 offset:50176
    ds_read_b64_tr_b16 v[92:93], v41 offset:49152
    v_mfma_f32_32x32x16_bf16 v[240:255], v[124:127], v[116:119], v[240:255]
    ds_read_b64_tr_b16 v[94:95], v41 offset:50176
    ds_read_b128 v[84:87], v32 offset:53248
    v_mfma_f32_32x32x16_bf16 v[192:207], v[136:139], v[128:131], v[192:207]
    ds_read_b128 v[96:99], v33 offset:49152
    ds_read_b64_tr_b16 v[104:105], v42 offset:53248
    v_mfma_f32_32x32x16_bf16 v[208:223], v[140:143], v[128:131], v[208:223]
    ds_read_b64_tr_b16 v[106:107], v42 offset:54272
    ds_read_b64_tr_b16 v[108:109], v43 offset:53248
    v_mfma_f32_32x32x16_bf16 v[224:239], v[136:139], v[132:135], v[224:239]
    ds_read_b64_tr_b16 v[110:111], v43 offset:54272
    ds_read_b128 v[100:103], v33 offset:53248
    v_mfma_f32_32x32x16_bf16 v[240:255], v[140:143], v[132:135], v[240:255]
    s_waitcnt lgkmcnt(6)
    v_mfma_f32_32x32x16_bf16 v[192:207], v[88:91], v[80:83], v[192:207]
    ds_read_b128 v[112:115], v34 offset:49152
    ds_read_b64_tr_b16 v[120:121], v40 offset:57344
    v_mfma_f32_32x32x16_bf16 v[208:223], v[92:95], v[80:83], v[208:223]
    ds_read_b64_tr_b16 v[122:123], v40 offset:58368
    ds_read_b64_tr_b16 v[124:125], v41 offset:57344
    v_mfma_f32_16x16x32_bf16 v[72:75], v[44:47], v[88:91], v[72:75]
    v_mfma_f32_32x32x16_bf16 v[224:239], v[88:91], v[84:87], v[224:239]
    ds_read_b64_tr_b16 v[126:127], v41 offset:58368
    ds_read_b128 v[116:119], v34 offset:53248
    v_mfma_f32_32x32x16_bf16 v[240:255], v[92:95], v[84:87], v[240:255]
    v_mfma_f32_16x16x32_bf16 v[76:79], v[44:47], v[92:95], v[76:79]
    s_waitcnt lgkmcnt(6)
    v_mfma_f32_32x32x16_bf16 v[192:207], v[104:107], v[96:99], v[192:207]
    ds_read_b128 v[128:131], v35 offset:49152
    ds_read_b64_tr_b16 v[136:137], v42 offset:61440
    v_mfma_f32_32x32x16_bf16 v[208:223], v[108:111], v[96:99], v[208:223]
    ds_read_b64_tr_b16 v[138:139], v42 offset:62464
    ds_read_b64_tr_b16 v[140:141], v43 offset:61440
    v_mfma_f32_32x32x16_bf16 v[224:239], v[104:107], v[100:103], v[224:239]
    ds_read_b64_tr_b16 v[142:143], v43 offset:62464
    ds_read_b128 v[132:135], v35 offset:53248
    v_mfma_f32_32x32x16_bf16 v[240:255], v[108:111], v[100:103], v[240:255]
    s_waitcnt lgkmcnt(6)
    v_mfma_f32_32x32x16_bf16 v[192:207], v[120:123], v[112:115], v[192:207]
    v_mfma_f32_16x16x32_bf16 v[72:75], v[44:47], v[120:123], v[72:75]
    v_mfma_f32_16x16x32_bf16 v[76:79], v[44:47], v[124:127], v[76:79]
    s_waitcnt lgkmcnt(0)
    s_barrier
    v_mfma_f32_32x32x16_bf16 v[208:223], v[124:127], v[112:115], v[208:223]
    ds_read_b128 v[80:83], v36 offset:0
    ds_read_b64_tr_b16 v[88:89], v40 offset:0
    v_mfma_f32_32x32x16_bf16 v[224:239], v[120:123], v[116:119], v[224:239]
    ds_read_b64_tr_b16 v[90:91], v40 offset:1024
    ds_read_b64_tr_b16 v[92:93], v41 offset:0
    v_mfma_f32_32x32x16_bf16 v[240:255], v[124:127], v[116:119], v[240:255]
    ds_read_b64_tr_b16 v[94:95], v41 offset:1024
    ds_read_b128 v[84:87], v36 offset:4096
    v_mfma_f32_32x32x16_bf16 v[192:207], v[136:139], v[128:131], v[192:207]
    ds_read_b128 v[96:99], v37 offset:0
    ds_read_b64_tr_b16 v[104:105], v42 offset:4096
    v_mfma_f32_32x32x16_bf16 v[208:223], v[140:143], v[128:131], v[208:223]
    ds_read_b64_tr_b16 v[106:107], v42 offset:5120
    ds_read_b64_tr_b16 v[108:109], v43 offset:4096
    v_mfma_f32_32x32x16_bf16 v[224:239], v[136:139], v[132:135], v[224:239]
    ds_read_b64_tr_b16 v[110:111], v43 offset:5120
    ds_read_b128 v[100:103], v37 offset:4096
    v_mfma_f32_32x32x16_bf16 v[240:255], v[140:143], v[132:135], v[240:255]
    s_waitcnt lgkmcnt(6)
    v_mfma_f32_32x32x16_bf16 v[192:207], v[88:91], v[80:83], v[192:207]
    ds_read_b128 v[112:115], v38 offset:0
    ds_read_b64_tr_b16 v[120:121], v40 offset:8192
    v_mfma_f32_32x32x16_bf16 v[208:223], v[92:95], v[80:83], v[208:223]
    ds_read_b64_tr_b16 v[122:123], v40 offset:9216
    ds_read_b64_tr_b16 v[124:125], v41 offset:8192
    v_mfma_f32_16x16x32_bf16 v[72:75], v[44:47], v[88:91], v[72:75]
    v_mfma_f32_32x32x16_bf16 v[224:239], v[88:91], v[84:87], v[224:239]
    ds_read_b64_tr_b16 v[126:127], v41 offset:9216
    ds_read_b128 v[116:119], v38 offset:4096
    v_mfma_f32_32x32x16_bf16 v[240:255], v[92:95], v[84:87], v[240:255]
    v_mfma_f32_16x16x32_bf16 v[76:79], v[44:47], v[92:95], v[76:79]
    s_waitcnt lgkmcnt(6)
    v_mfma_f32_32x32x16_bf16 v[192:207], v[104:107], v[96:99], v[192:207]
    ds_read_b128 v[128:131], v39 offset:0
    ds_read_b64_tr_b16 v[136:137], v42 offset:12288
    v_mfma_f32_32x32x16_bf16 v[208:223], v[108:111], v[96:99], v[208:223]
    ds_read_b64_tr_b16 v[138:139], v42 offset:13312
    ds_read_b64_tr_b16 v[140:141], v43 offset:12288
    v_mfma_f32_32x32x16_bf16 v[224:239], v[104:107], v[100:103], v[224:239]
    ds_read_b64_tr_b16 v[142:143], v43 offset:13312
    ds_read_b128 v[132:135], v39 offset:4096
    v_mfma_f32_32x32x16_bf16 v[240:255], v[108:111], v[100:103], v[240:255]
    s_waitcnt lgkmcnt(6)
    v_mfma_f32_32x32x16_bf16 v[192:207], v[120:123], v[112:115], v[192:207]
    v_mfma_f32_16x16x32_bf16 v[72:75], v[44:47], v[120:123], v[72:75]
    v_mfma_f32_16x16x32_bf16 v[76:79], v[44:47], v[124:127], v[76:79]
    s_waitcnt lgkmcnt(0)
    s_barrier
    v_mfma_f32_32x32x16_bf16 v[208:223], v[124:127], v[112:115], v[208:223]
    ds_read_b128 v[80:83], v32 offset:0
    ds_read_b64_tr_b16 v[88:89], v40 offset:16384
    v_mfma_f32_32x32x16_bf16 v[224:239], v[120:123], v[116:119], v[224:239]
    ds_read_b64_tr_b16 v[90:91], v40 offset:17408
    ds_read_b64_tr_b16 v[92:93], v41 offset:16384
    v_mfma_f32_32x32x16_bf16 v[240:255], v[124:127], v[116:119], v[240:255]
    ds_read_b64_tr_b16 v[94:95], v41 offset:17408
    ds_read_b128 v[84:87], v32 offset:4096
    v_mfma_f32_32x32x16_bf16 v[192:207], v[136:139], v[128:131], v[192:207]
    ds_read_b128 v[96:99], v33 offset:0
    ds_read_b64_tr_b16 v[104:105], v42 offset:20480
    v_mfma_f32_32x32x16_bf16 v[208:223], v[140:143], v[128:131], v[208:223]
    ds_read_b64_tr_b16 v[106:107], v42 offset:21504
    ds_read_b64_tr_b16 v[108:109], v43 offset:20480
    v_mfma_f32_32x32x16_bf16 v[224:239], v[136:139], v[132:135], v[224:239]
    ds_read_b64_tr_b16 v[110:111], v43 offset:21504
    ds_read_b128 v[100:103], v33 offset:4096
    v_mfma_f32_32x32x16_bf16 v[240:255], v[140:143], v[132:135], v[240:255]
    s_waitcnt lgkmcnt(6)
    v_mfma_f32_32x32x16_bf16 v[192:207], v[88:91], v[80:83], v[192:207]
    ds_read_b128 v[112:115], v34 offset:0
    ds_read_b64_tr_b16 v[120:121], v40 offset:24576
    v_mfma_f32_32x32x16_bf16 v[208:223], v[92:95], v[80:83], v[208:223]
    ds_read_b64_tr_b16 v[122:123], v40 offset:25600
    ds_read_b64_tr_b16 v[124:125], v41 offset:24576
    v_mfma_f32_16x16x32_bf16 v[72:75], v[44:47], v[88:91], v[72:75]
    v_mfma_f32_32x32x16_bf16 v[224:239], v[88:91], v[84:87], v[224:239]
    ds_read_b64_tr_b16 v[126:127], v41 offset:25600
    ds_read_b128 v[116:119], v34 offset:4096
    v_mfma_f32_32x32x16_bf16 v[240:255], v[92:95], v[84:87], v[240:255]
    v_mfma_f32_16x16x32_bf16 v[76:79], v[44:47], v[92:95], v[76:79]
    s_waitcnt lgkmcnt(6)
    v_mfma_f32_32x32x16_bf16 v[192:207], v[104:107], v[96:99], v[192:207]
    ds_read_b128 v[128:131], v35 offset:0
    ds_read_b64_tr_b16 v[136:137], v42 offset:28672
    v_mfma_f32_32x32x16_bf16 v[208:223], v[108:111], v[96:99], v[208:223]
    ds_read_b64_tr_b16 v[138:139], v42 offset:29696
    ds_read_b64_tr_b16 v[140:141], v43 offset:28672
    v_mfma_f32_32x32x16_bf16 v[224:239], v[104:107], v[100:103], v[224:239]
    ds_read_b64_tr_b16 v[142:143], v43 offset:29696
    ds_read_b128 v[132:135], v35 offset:4096
    v_mfma_f32_32x32x16_bf16 v[240:255], v[108:111], v[100:103], v[240:255]
    s_waitcnt lgkmcnt(6)
    v_mfma_f32_32x32x16_bf16 v[192:207], v[120:123], v[112:115], v[192:207]
    v_mfma_f32_16x16x32_bf16 v[72:75], v[44:47], v[120:123], v[72:75]
    v_mfma_f32_16x16x32_bf16 v[76:79], v[44:47], v[124:127], v[76:79]
    s_waitcnt lgkmcnt(0)
    s_barrier
    v_mfma_f32_32x32x16_bf16 v[208:223], v[124:127], v[112:115], v[208:223]
    ds_read_b128 v[80:83], v32 offset:16384
    ds_read_b64_tr_b16 v[88:89], v40 offset:32768
    v_mfma_f32_32x32x16_bf16 v[224:239], v[120:123], v[116:119], v[224:239]
    ds_read_b64_tr_b16 v[90:91], v40 offset:33792
    ds_read_b64_tr_b16 v[92:93], v41 offset:32768
    v_mfma_f32_32x32x16_bf16 v[240:255], v[124:127], v[116:119], v[240:255]
    ds_read_b64_tr_b16 v[94:95], v41 offset:33792
    ds_read_b128 v[84:87], v32 offset:20480
    v_mfma_f32_32x32x16_bf16 v[192:207], v[136:139], v[128:131], v[192:207]
    ds_read_b128 v[96:99], v33 offset:16384
    ds_read_b64_tr_b16 v[104:105], v42 offset:36864
    v_mfma_f32_32x32x16_bf16 v[208:223], v[140:143], v[128:131], v[208:223]
    ds_read_b64_tr_b16 v[106:107], v42 offset:37888
    ds_read_b64_tr_b16 v[108:109], v43 offset:36864
    v_mfma_f32_32x32x16_bf16 v[224:239], v[136:139], v[132:135], v[224:239]
    ds_read_b64_tr_b16 v[110:111], v43 offset:37888
    ds_read_b128 v[100:103], v33 offset:20480
    v_mfma_f32_32x32x16_bf16 v[240:255], v[140:143], v[132:135], v[240:255]
    s_waitcnt lgkmcnt(6)
    v_mfma_f32_32x32x16_bf16 v[192:207], v[88:91], v[80:83], v[192:207]
    ds_read_b128 v[112:115], v34 offset:16384
    ds_read_b64_tr_b16 v[120:121], v40 offset:40960
    v_mfma_f32_32x32x16_bf16 v[208:223], v[92:95], v[80:83], v[208:223]
    ds_read_b64_tr_b16 v[122:123], v40 offset:41984
    ds_read_b64_tr_b16 v[124:125], v41 offset:40960
    v_mfma_f32_16x16x32_bf16 v[72:75], v[44:47], v[88:91], v[72:75]
    v_mfma_f32_32x32x16_bf16 v[224:239], v[88:91], v[84:87], v[224:239]
    ds_read_b64_tr_b16 v[126:127], v41 offset:41984
    ds_read_b128 v[116:119], v34 offset:20480
    v_mfma_f32_32x32x16_bf16 v[240:255], v[92:95], v[84:87], v[240:255]
    v_mfma_f32_16x16x32_bf16 v[76:79], v[44:47], v[92:95], v[76:79]
    s_waitcnt lgkmcnt(6)
    v_mfma_f32_32x32x16_bf16 v[192:207], v[104:107], v[96:99], v[192:207]
    ds_read_b128 v[128:131], v35 offset:16384
    ds_read_b64_tr_b16 v[136:137], v42 offset:45056
    v_mfma_f32_32x32x16_bf16 v[208:223], v[108:111], v[96:99], v[208:223]
    ds_read_b64_tr_b16 v[138:139], v42 offset:46080
    ds_read_b64_tr_b16 v[140:141], v43 offset:45056
    v_mfma_f32_32x32x16_bf16 v[224:239], v[104:107], v[100:103], v[224:239]
    ds_read_b64_tr_b16 v[142:143], v43 offset:46080
    ds_read_b128 v[132:135], v35 offset:20480
    v_mfma_f32_32x32x16_bf16 v[240:255], v[108:111], v[100:103], v[240:255]
    s_waitcnt lgkmcnt(6)
    v_mfma_f32_32x32x16_bf16 v[192:207], v[120:123], v[112:115], v[192:207]
    v_mfma_f32_16x16x32_bf16 v[72:75], v[44:47], v[120:123], v[72:75]
    v_mfma_f32_16x16x32_bf16 v[76:79], v[44:47], v[124:127], v[76:79]
    s_waitcnt lgkmcnt(0)
    s_barrier
    v_mfma_f32_32x32x16_bf16 v[208:223], v[124:127], v[112:115], v[208:223]
    ds_read_b128 v[80:83], v32 offset:32768
    ds_read_b64_tr_b16 v[88:89], v40 offset:49152
    v_mfma_f32_32x32x16_bf16 v[224:239], v[120:123], v[116:119], v[224:239]
    ds_read_b64_tr_b16 v[90:91], v40 offset:50176
    ds_read_b64_tr_b16 v[92:93], v41 offset:49152
    v_mfma_f32_32x32x16_bf16 v[240:255], v[124:127], v[116:119], v[240:255]
    ds_read_b64_tr_b16 v[94:95], v41 offset:50176
    ds_read_b128 v[84:87], v32 offset:36864
    v_mfma_f32_32x32x16_bf16 v[192:207], v[136:139], v[128:131], v[192:207]
    ds_read_b128 v[96:99], v33 offset:32768
    ds_read_b64_tr_b16 v[104:105], v42 offset:53248
    v_mfma_f32_32x32x16_bf16 v[208:223], v[140:143], v[128:131], v[208:223]
    ds_read_b64_tr_b16 v[106:107], v42 offset:54272
    ds_read_b64_tr_b16 v[108:109], v43 offset:53248
    v_mfma_f32_32x32x16_bf16 v[224:239], v[136:139], v[132:135], v[224:239]
    ds_read_b64_tr_b16 v[110:111], v43 offset:54272
    ds_read_b128 v[100:103], v33 offset:36864
    v_mfma_f32_32x32x16_bf16 v[240:255], v[140:143], v[132:135], v[240:255]
    s_waitcnt lgkmcnt(6)
    v_mfma_f32_32x32x16_bf16 v[192:207], v[88:91], v[80:83], v[192:207]
    ds_read_b128 v[112:115], v34 offset:32768
    ds_read_b64_tr_b16 v[120:121], v40 offset:57344
    v_mfma_f32_32x32x16_bf16 v[208:223], v[92:95], v[80:83], v[208:223]
    ds_read_b64_tr_b16 v[122:123], v40 offset:58368
    ds_read_b64_tr_b16 v[124:125], v41 offset:57344
    v_mfma_f32_16x16x32_bf16 v[72:75], v[44:47], v[88:91], v[72:75]
    v_mfma_f32_32x32x16_bf16 v[224:239], v[88:91], v[84:87], v[224:239]
    ds_read_b64_tr_b16 v[126:127], v41 offset:58368
    ds_read_b128 v[116:119], v34 offset:36864
    v_mfma_f32_32x32x16_bf16 v[240:255], v[92:95], v[84:87], v[240:255]
    v_mfma_f32_16x16x32_bf16 v[76:79], v[44:47], v[92:95], v[76:79]
    s_waitcnt lgkmcnt(6)
    v_mfma_f32_32x32x16_bf16 v[192:207], v[104:107], v[96:99], v[192:207]
    ds_read_b128 v[128:131], v35 offset:32768
    ds_read_b64_tr_b16 v[136:137], v42 offset:61440
    v_mfma_f32_32x32x16_bf16 v[208:223], v[108:111], v[96:99], v[208:223]
    ds_read_b64_tr_b16 v[138:139], v42 offset:62464
    ds_read_b64_tr_b16 v[140:141], v43 offset:61440
    v_mfma_f32_32x32x16_bf16 v[224:239], v[104:107], v[100:103], v[224:239]
    ds_read_b64_tr_b16 v[142:143], v43 offset:62464
    ds_read_b128 v[132:135], v35 offset:36864
    v_mfma_f32_32x32x16_bf16 v[240:255], v[108:111], v[100:103], v[240:255]
    s_waitcnt lgkmcnt(6)
    v_mfma_f32_32x32x16_bf16 v[192:207], v[120:123], v[112:115], v[192:207]
    v_mfma_f32_16x16x32_bf16 v[72:75], v[44:47], v[120:123], v[72:75]
    v_mfma_f32_16x16x32_bf16 v[76:79], v[44:47], v[124:127], v[76:79]
    s_waitcnt lgkmcnt(0)
    s_barrier
    v_mfma_f32_32x32x16_bf16 v[208:223], v[124:127], v[112:115], v[208:223]
    ds_read_b128 v[80:83], v32 offset:49152
    ds_read_b64_tr_b16 v[88:89], v40 offset:0
    v_mfma_f32_32x32x16_bf16 v[224:239], v[120:123], v[116:119], v[224:239]
    ds_read_b64_tr_b16 v[90:91], v40 offset:1024
    ds_read_b64_tr_b16 v[92:93], v41 offset:0
    v_mfma_f32_32x32x16_bf16 v[240:255], v[124:127], v[116:119], v[240:255]
    ds_read_b64_tr_b16 v[94:95], v41 offset:1024
    ds_read_b128 v[84:87], v32 offset:53248
    v_mfma_f32_32x32x16_bf16 v[192:207], v[136:139], v[128:131], v[192:207]
    ds_read_b128 v[96:99], v33 offset:49152
    ds_read_b64_tr_b16 v[104:105], v42 offset:4096
    v_mfma_f32_32x32x16_bf16 v[208:223], v[140:143], v[128:131], v[208:223]
    ds_read_b64_tr_b16 v[106:107], v42 offset:5120
    ds_read_b64_tr_b16 v[108:109], v43 offset:4096
    v_mfma_f32_32x32x16_bf16 v[224:239], v[136:139], v[132:135], v[224:239]
    ds_read_b64_tr_b16 v[110:111], v43 offset:5120
    ds_read_b128 v[100:103], v33 offset:53248
    v_mfma_f32_32x32x16_bf16 v[240:255], v[140:143], v[132:135], v[240:255]
    buffer_load_dwordx4 v[48:51], v14, s[24:27], s56 offen sc1
    buffer_load_dwordx4 v[52:55], v14, s[24:27], s56 offen offset:512 sc1
    buffer_load_dwordx4 v[56:59], v15, s[24:27], s56 offen sc1
    v_mov_b32 v13, 0
    buffer_load_dword v12, v13, s[28:31], 0 offen sc1
    s_waitcnt lgkmcnt(6)
    v_mfma_f32_32x32x16_bf16 v[192:207], v[88:91], v[80:83], v[192:207]
    ds_read_b128 v[112:115], v34 offset:49152
    ds_read_b64_tr_b16 v[120:121], v40 offset:8192
    v_mfma_f32_32x32x16_bf16 v[208:223], v[92:95], v[80:83], v[208:223]
    ds_read_b64_tr_b16 v[122:123], v40 offset:9216
    ds_read_b64_tr_b16 v[124:125], v41 offset:8192
    v_mfma_f32_16x16x32_bf16 v[72:75], v[44:47], v[88:91], v[72:75]
    v_mfma_f32_32x32x16_bf16 v[224:239], v[88:91], v[84:87], v[224:239]
    ds_read_b64_tr_b16 v[126:127], v41 offset:9216
    ds_read_b128 v[116:119], v34 offset:53248
    v_mfma_f32_32x32x16_bf16 v[240:255], v[92:95], v[84:87], v[240:255]
    v_mfma_f32_16x16x32_bf16 v[76:79], v[44:47], v[92:95], v[76:79]
    s_waitcnt lgkmcnt(6)
    v_mfma_f32_32x32x16_bf16 v[192:207], v[104:107], v[96:99], v[192:207]
    ds_read_b128 v[128:131], v35 offset:49152
    ds_read_b64_tr_b16 v[136:137], v42 offset:12288
    v_mfma_f32_32x32x16_bf16 v[208:223], v[108:111], v[96:99], v[208:223]
    ds_read_b64_tr_b16 v[138:139], v42 offset:13312
    ds_read_b64_tr_b16 v[140:141], v43 offset:12288
    v_mfma_f32_32x32x16_bf16 v[224:239], v[104:107], v[100:103], v[224:239]
    ds_read_b64_tr_b16 v[142:143], v43 offset:13312
    ds_read_b128 v[132:135], v35 offset:53248
    v_mfma_f32_32x32x16_bf16 v[240:255], v[108:111], v[100:103], v[240:255]
    s_waitcnt lgkmcnt(6)
    v_mfma_f32_32x32x16_bf16 v[192:207], v[120:123], v[112:115], v[192:207]
    v_mfma_f32_16x16x32_bf16 v[72:75], v[44:47], v[120:123], v[72:75]
    v_mfma_f32_16x16x32_bf16 v[76:79], v[44:47], v[124:127], v[76:79]
    s_waitcnt lgkmcnt(0)
    s_barrier
    v_mfma_f32_32x32x16_bf16 v[208:223], v[124:127], v[112:115], v[208:223]
    ds_read_b128 v[80:83], v36 offset:0
    ds_read_b64_tr_b16 v[88:89], v40 offset:16384
    v_mfma_f32_32x32x16_bf16 v[224:239], v[120:123], v[116:119], v[224:239]
    ds_read_b64_tr_b16 v[90:91], v40 offset:17408
    ds_read_b64_tr_b16 v[92:93], v41 offset:16384
    v_mfma_f32_32x32x16_bf16 v[240:255], v[124:127], v[116:119], v[240:255]
    ds_read_b64_tr_b16 v[94:95], v41 offset:17408
    ds_read_b128 v[84:87], v36 offset:4096
    v_mfma_f32_32x32x16_bf16 v[192:207], v[136:139], v[128:131], v[192:207]
    ds_read_b128 v[96:99], v37 offset:0
    ds_read_b64_tr_b16 v[104:105], v42 offset:20480
    v_mfma_f32_32x32x16_bf16 v[208:223], v[140:143], v[128:131], v[208:223]
    ds_read_b64_tr_b16 v[106:107], v42 offset:21504
    ds_read_b64_tr_b16 v[108:109], v43 offset:20480
    v_mfma_f32_32x32x16_bf16 v[224:239], v[136:139], v[132:135], v[224:239]
    ds_read_b64_tr_b16 v[110:111], v43 offset:21504
    ds_read_b128 v[100:103], v37 offset:4096
    v_mfma_f32_32x32x16_bf16 v[240:255], v[140:143], v[132:135], v[240:255]
    s_waitcnt lgkmcnt(6)
    v_mfma_f32_32x32x16_bf16 v[192:207], v[88:91], v[80:83], v[192:207]
    ds_read_b128 v[112:115], v38 offset:0
    ds_read_b64_tr_b16 v[120:121], v40 offset:24576
    v_mfma_f32_32x32x16_bf16 v[208:223], v[92:95], v[80:83], v[208:223]
    ds_read_b64_tr_b16 v[122:123], v40 offset:25600
    ds_read_b64_tr_b16 v[124:125], v41 offset:24576
    v_mfma_f32_16x16x32_bf16 v[72:75], v[44:47], v[88:91], v[72:75]
    v_mfma_f32_32x32x16_bf16 v[224:239], v[88:91], v[84:87], v[224:239]
    ds_read_b64_tr_b16 v[126:127], v41 offset:25600
    ds_read_b128 v[116:119], v38 offset:4096
    v_mfma_f32_32x32x16_bf16 v[240:255], v[92:95], v[84:87], v[240:255]
    v_mfma_f32_16x16x32_bf16 v[76:79], v[44:47], v[92:95], v[76:79]
    s_waitcnt lgkmcnt(6)
    v_mfma_f32_32x32x16_bf16 v[192:207], v[104:107], v[96:99], v[192:207]
    ds_read_b128 v[128:131], v39 offset:0
    ds_read_b64_tr_b16 v[136:137], v42 offset:28672
    v_mfma_f32_32x32x16_bf16 v[208:223], v[108:111], v[96:99], v[208:223]
    ds_read_b64_tr_b16 v[138:139], v42 offset:29696
    ds_read_b64_tr_b16 v[140:141], v43 offset:28672
    v_mfma_f32_32x32x16_bf16 v[224:239], v[104:107], v[100:103], v[224:239]
    ds_read_b64_tr_b16 v[142:143], v43 offset:29696
    ds_read_b128 v[132:135], v39 offset:4096
    v_mfma_f32_32x32x16_bf16 v[240:255], v[108:111], v[100:103], v[240:255]
    s_waitcnt lgkmcnt(6)
    v_mfma_f32_32x32x16_bf16 v[192:207], v[120:123], v[112:115], v[192:207]
    v_mfma_f32_16x16x32_bf16 v[72:75], v[44:47], v[120:123], v[72:75]
    v_mfma_f32_16x16x32_bf16 v[76:79], v[44:47], v[124:127], v[76:79]
    s_waitcnt lgkmcnt(0)
    s_barrier
    v_mfma_f32_32x32x16_bf16 v[208:223], v[124:127], v[112:115], v[208:223]
    ds_read_b128 v[80:83], v20 offset:0
    ds_read_b64_tr_b16 v[84:85], v24 offset:32768
    ds_read_b64_tr_b16 v[86:87], v24 offset:33792
    v_mfma_f32_32x32x16_bf16 v[224:239], v[120:123], v[116:119], v[224:239]
    ds_read_b64_tr_b16 v[88:89], v25 offset:32768
    ds_read_b64_tr_b16 v[90:91], v25 offset:33792
    ds_read_b64_tr_b16 v[92:93], v26 offset:32768
    v_mfma_f32_32x32x16_bf16 v[240:255], v[124:127], v[116:119], v[240:255]
    ds_read_b64_tr_b16 v[94:95], v26 offset:33792
    v_mfma_f32_32x32x16_bf16 v[192:207], v[136:139], v[128:131], v[192:207]
    ds_read_b128 v[96:99], v21 offset:0
    ds_read_b64_tr_b16 v[100:101], v27 offset:36864
    v_mfma_f32_32x32x16_bf16 v[208:223], v[140:143], v[128:131], v[208:223]
    ds_read_b64_tr_b16 v[102:103], v27 offset:37888
    ds_read_b64_tr_b16 v[104:105], v28 offset:36864
    v_mfma_f32_32x32x16_bf16 v[224:239], v[136:139], v[132:135], v[224:239]
    ds_read_b64_tr_b16 v[106:107], v28 offset:37888
    ds_read_b64_tr_b16 v[108:109], v29 offset:36864
    v_mfma_f32_32x32x16_bf16 v[240:255], v[140:143], v[132:135], v[240:255]
    ds_read_b64_tr_b16 v[110:111], v29 offset:37888
    s_waitcnt vmcnt(0)
    s_mov_b32 s73, 0
P1C_nc_l:
    v_readfirstlane_b32 s3, v12
    s_add_u32 s73, s73, 1
    s_cmp_lg_u32 s3, 0
    s_cbranch_scc1 P1C_nc_ok
    s_cmp_lt_u32 s73, 200000
    s_cbranch_scc0 P1C_nc_ok
    v_mov_b32 v13, 0
    buffer_load_dword v12, v13, s[28:31], 0 offen sc1
    s_waitcnt vmcnt(0)
    s_branch P1C_nc_l
P1C_nc_ok:
    s_mov_b32 s72, 0
P1C_sl:
    v_xor_b32 v50, s3, v50
    v_xor_b32 v54, s3, v54
    v_xor_b32 v58, s3, v58
    v_or3_b32 v9, v50, v54, v58
    v_cmp_ne_u32 vcc, 0, v9
    s_add_u32 s72, s72, 1
    s_cbranch_vccz P1C_sok
    s_cmp_lt_u32 s72, 200000
    s_cbranch_scc0 P1C_sok
    buffer_load_dwordx4 v[48:51], v14, s[24:27], s56 offen sc1
    buffer_load_dwordx4 v[52:55], v14, s[24:27], s56 offen offset:512 sc1
    buffer_load_dwordx4 v[56:59], v15, s[24:27], s56 offen sc1
    s_waitcnt vmcnt(0)
    s_branch P1C_sl
P1C_sok:
    s_cmp_eq_u32 s37, 1
    s_cselect_b64 vcc, -1, 0
    s_waitcnt lgkmcnt(7)
    v_mfma_f32_32x32x16_bf16 v[144:159], v[84:87], v[80:83], 0
    ds_read_b128 v[112:115], v22 offset:0
    ds_read_b64_tr_b16 v[116:117], v24 offset:40960
    ds_read_b64_tr_b16 v[118:119], v24 offset:41984
    s_mov_b64 exec, 0xffff
    ds_write2st64_b32 v5, v72, v73 offset0:0 offset1:1
    ds_write2st64_b32 v5, v76, v77 offset0:2 offset1:3
    s_mov_b64 exec, -1
    v_mul_f32 v48, 0x3acccccd, v48
    v_mul_f32 v49, 0x3acccccd, v49
    v_fma_f32 v49, -v48, v48, v49
    v_max_f32 v49, 0, v49
    v_cvt_pk_bf16_f32 v49, v49, v49
    v_and_b32 v49, 0xffff0000, v49
    v_add_f32 v49, 0x3727c5ac, v49
    v_cvt_pk_bf16_f32 v49, v49, v49
    v_and_b32 v49, 0xffff0000, v49
    v_sqrt_f32 v49, v49
    v_mfma_f32_32x32x16_bf16 v[160:175], v[88:91], v[80:83], 0
    ds_read_b64_tr_b16 v[120:121], v25 offset:40960
    ds_read_b64_tr_b16 v[122:123], v25 offset:41984
    ds_read_b64_tr_b16 v[124:125], v26 offset:40960
    v_cvt_pk_bf16_f32 v48, -v48, -v48
    v_cvt_pk_bf16_f32 v49, v49, v49
    v_and_b32 v49, 0xffff0000, v49
    v_rcp_f32 v50, v49
    v_cndmask_b32 v54, 0, v48, s[60:61]
    v_and_b32 v55, 0xffff, v54
    v_mul_f32 v52, 0x3acccccd, v52
    v_mul_f32 v53, 0x3acccccd, v53
    v_fma_f32 v53, -v52, v52, v53
    v_max_f32 v53, 0, v53
    v_cvt_pk_bf16_f32 v53, v53, v53
    v_and_b32 v53, 0xffff0000, v53
    v_add_f32 v53, 0x3727c5ac, v53
    v_cvt_pk_bf16_f32 v53, v53, v53
    v_mfma_f32_32x32x16_bf16 v[176:191], v[92:95], v[80:83], 0
    s_waitcnt lgkmcnt(14)
    ds_read_b64_tr_b16 v[126:127], v26 offset:41984
    v_and_b32 v53, 0xffff0000, v53
    v_sqrt_f32 v53, v53
    v_cvt_pk_bf16_f32 v52, -v52, -v52
    v_cvt_pk_bf16_f32 v53, v53, v53
    v_and_b32 v53, 0xffff0000, v53
    v_rcp_f32 v51, v53
    v_cndmask_b32 v30, 0, v52, s[60:61]
    v_and_b32 v31, 0xffff, v30
    s_cmp_lt_u32 s36, 5
    s_cselect_b32 s15, 0x3ea52b5c, 1.0
    v_mul_f32 v50, s15, v50
    v_mul_f32 v51, s15, v51
    s_bfe_u32 s15, s43, 131072
    s_lshl_b32 s15, s15, 6
    v_xor_b32 v12, s15, v8
    s_bfe_u32 s15, s43, 131074
    s_lshl_b32 s15, s15, 6
    v_xor_b32 v13, s15, v8
    s_cbranch_vccnz P1C_nc10_0
    v_mfma_f32_16x16x32_bf16 v[60:63], v[44:47], v[84:87], v[60:63]
    v_mfma_f32_16x16x32_bf16 v[64:67], v[44:47], v[88:91], v[64:67]
    v_mfma_f32_16x16x32_bf16 v[68:71], v[44:47], v[92:95], v[68:71]
P1C_nc10_0:
    s_waitcnt lgkmcnt(9)
    v_mfma_f32_32x32x16_bf16 v[144:159], v[100:103], v[96:99], v[144:159]
    ds_read_b128 v[128:131], v23 offset:0
    ds_read_b64_tr_b16 v[132:133], v27 offset:45056
    ds_read_b64_tr_b16 v[134:135], v27 offset:46080
    s_bfe_u32 s15, s43, 131076
    s_lshl_b32 s15, s15, 6
    v_xor_b32 v14, s15, v8
    s_bfe_u32 s15, s43, 131078
    s_lshl_b32 s15, s15, 6
    v_xor_b32 v15, s15, v8
    s_bfe_u32 s15, s43, 131080
    s_lshl_b32 s15, s15, 6
    v_xor_b32 v11, s15, v8
    s_lshl_b32 s15, s38, 3
    v_add_u32 v9, s15, v6
    v_mfma_f32_32x32x16_bf16 v[160:175], v[104:107], v[96:99], v[160:175]
    ds_read_b64_tr_b16 v[136:137], v28 offset:45056
    ds_read_b64_tr_b16 v[138:139], v28 offset:46080
    ds_read_b64_tr_b16 v[140:141], v29 offset:45056
    v_mfma_f32_32x32x16_bf16 v[176:191], v[108:111], v[96:99], v[176:191]
    s_waitcnt lgkmcnt(14)
    ds_read_b64_tr_b16 v[142:143], v29 offset:46080
    s_waitcnt lgkmcnt(7)
    v_mfma_f32_32x32x16_bf16 v[144:159], v[116:119], v[112:115], v[144:159]
    s_waitcnt lgkmcnt(0)
    s_barrier
    v_mfma_f32_32x32x16_bf16 v[160:175], v[120:123], v[112:115], v[160:175]
    ds_read_b128 v[80:83], v16 offset:49152
    ds_read_b64_tr_b16 v[84:85], v24 offset:49152
    ds_read_b64_tr_b16 v[86:87], v24 offset:50176
    ds_read_b64_tr_b16 v[88:89], v25 offset:49152
    ds_read_b64 v[72:73], v9 offset:0
    ds_read_b64 v[74:75], v9 offset:512
    v_mfma_f32_32x32x16_bf16 v[176:191], v[124:127], v[112:115], v[176:191]
    ds_read_b64_tr_b16 v[90:91], v25 offset:50176
    ds_read_b64_tr_b16 v[92:93], v26 offset:49152
    ds_read_b64_tr_b16 v[94:95], v26 offset:50176
    s_waitcnt lgkmcnt(3)
    v_add_f32 v72, v72, v73
    v_cvt_pk_bf16_f32 v9, v72, v72
    v_and_b32 v9, 0xffff0000, v9
    v_sub_f32 v9, v72, v9
    v_cvt_pk_bf16_f32 v76, v72, v9
    v_and_b32 v10, 0xffff0000, v76
    v_sub_f32 v9, v9, v10
    v_cvt_pk_bf16_f32 v77, v9, 0
    s_nop 1
    v_mfma_f32_32x32x8_bf16 v[192:207], v[76:77], v[54:55], v[192:207]
    s_cbranch_vccz P1C_nc10_2
    v_mfma_f32_16x16x32_bf16 v[60:63], v[44:47], v[116:119], v[60:63]
    v_mfma_f32_16x16x32_bf16 v[64:67], v[44:47], v[120:123], v[64:67]
    v_mfma_f32_16x16x32_bf16 v[68:71], v[44:47], v[124:127], v[68:71]
P1C_nc10_2:
    v_mfma_f32_32x32x16_bf16 v[144:159], v[132:135], v[128:131], v[144:159]
    ds_read_b128 v[96:99], v17 offset:49152
    ds_read_b64_tr_b16 v[100:101], v27 offset:53248
    ds_read_b64_tr_b16 v[102:103], v27 offset:54272
    v_mfma_f32_32x32x8_bf16 v[224:239], v[76:77], v[30:31], v[224:239]
    v_add_f32 v74, v74, v75
    v_cvt_pk_bf16_f32 v9, v74, v74
    v_and_b32 v9, 0xffff0000, v9
    v_sub_f32 v9, v74, v9
    v_cvt_pk_bf16_f32 v78, v74, v9
    v_and_b32 v10, 0xffff0000, v78
    v_sub_f32 v9, v9, v10
    v_mfma_f32_32x32x16_bf16 v[160:175], v[136:139], v[128:131], v[160:175]
    ds_read_b64_tr_b16 v[104:105], v28 offset:53248
    ds_read_b64_tr_b16 v[106:107], v28 offset:54272
    ds_read_b64_tr_b16 v[108:109], v29 offset:53248
    v_cvt_pk_bf16_f32 v79, v9, 0
    s_nop 1
    v_mfma_f32_32x32x8_bf16 v[208:223], v[78:79], v[54:55], v[208:223]
    v_mfma_f32_32x32x8_bf16 v[240:255], v[78:79], v[30:31], v[240:255]
    v_mfma_f32_32x32x16_bf16 v[176:191], v[140:143], v[128:131], v[176:191]
    ds_read_b64_tr_b16 v[110:111], v29 offset:54272
    v_mul_f32 v192, v192, v50
    v_mul_f32 v193, v193, v50
    v_mul_f32 v194, v194, v50
    v_mul_f32 v195, v195, v50
    v_mul_f32 v224, v224, v51
    v_mul_f32 v225, v225, v51
    v_mul_f32 v226, v226, v51
    v_mul_f32 v227, v227, v51
    v_cvt_pk_bf16_f32 v32, v192, v193
    v_cvt_pk_bf16_f32 v33, v194, v195
    v_cvt_pk_bf16_f32 v34, v224, v225
    v_cvt_pk_bf16_f32 v35, v226, v227
    s_nop 1
    v_permlane32_swap_b32 v32, v34
    v_permlane32_swap_b32 v33, v35
    buffer_store_dwordx4 v[32:35], v12, s[24:27], s54 offen sc1
    s_waitcnt lgkmcnt(7)
    v_mfma_f32_32x32x16_bf16 v[144:159], v[84:87], v[80:83], v[144:159]
    ds_read_b128 v[112:115], v18 offset:49152
    ds_read_b64_tr_b16 v[116:117], v24 offset:57344
    ds_read_b64_tr_b16 v[118:119], v24 offset:58368
    s_add_u32 s54, s54, 32768
    v_mul_f32 v196, v196, v50
    v_mul_f32 v197, v197, v50
    v_mul_f32 v198, v198, v50
    v_mul_f32 v199, v199, v50
    v_mul_f32 v228, v228, v51
    v_mul_f32 v229, v229, v51
    v_mul_f32 v230, v230, v51
    v_mul_f32 v231, v231, v51
    v_cvt_pk_bf16_f32 v36, v196, v197
    v_cvt_pk_bf16_f32 v37, v198, v199
    v_cvt_pk_bf16_f32 v38, v228, v229
    v_cvt_pk_bf16_f32 v39, v230, v231
    s_nop 1
    v_permlane32_swap_b32 v36, v38
    v_mfma_f32_32x32x16_bf16 v[160:175], v[88:91], v[80:83], v[160:175]
    ds_read_b64_tr_b16 v[120:121], v25 offset:57344
    ds_read_b64_tr_b16 v[122:123], v25 offset:58368
    ds_read_b64_tr_b16 v[124:125], v26 offset:57344
    v_permlane32_swap_b32 v37, v39
    buffer_store_dwordx4 v[36:39], v13, s[24:27], s54 offen sc1
    s_add_u32 s54, s54, 32768
    v_mul_f32 v200, v200, v50
    v_mul_f32 v201, v201, v50
    v_mul_f32 v202, v202, v50
    v_mul_f32 v203, v203, v50
    v_mul_f32 v232, v232, v51
    v_mul_f32 v233, v233, v51
    v_mul_f32 v234, v234, v51
    v_mul_f32 v235, v235, v51
    v_cvt_pk_bf16_f32 v40, v200, v201
    v_mfma_f32_32x32x16_bf16 v[176:191], v[92:95], v[80:83], v[176:191]
    ds_read_b64_tr_b16 v[126:127], v26 offset:58368
    v_cvt_pk_bf16_f32 v41, v202, v203
    v_cvt_pk_bf16_f32 v42, v232, v233
    v_cvt_pk_bf16_f32 v43, v234, v235
    s_nop 1
    v_permlane32_swap_b32 v40, v42
    v_permlane32_swap_b32 v41, v43
    buffer_store_dwordx4 v[40:43], v14, s[24:27], s54 offen sc1
    s_add_u32 s54, s54, 32768
    v_mul_f32 v204, v204, v50
    v_mul_f32 v205, v205, v50
    v_mul_f32 v206, v206, v50
    v_mul_f32 v207, v207, v50
    v_mul_f32 v236, v236, v51
    v_mul_f32 v237, v237, v51
    s_cbranch_vccnz P1C_nc11_0
    v_mfma_f32_16x16x32_bf16 v[60:63], v[44:47], v[84:87], v[60:63]
    v_mfma_f32_16x16x32_bf16 v[64:67], v[44:47], v[88:91], v[64:67]
    v_mfma_f32_16x16x32_bf16 v[68:71], v[44:47], v[92:95], v[68:71]
P1C_nc11_0:
    s_waitcnt lgkmcnt(7)
    v_mfma_f32_32x32x16_bf16 v[144:159], v[100:103], v[96:99], v[144:159]
    ds_read_b128 v[128:131], v19 offset:49152
    ds_read_b64_tr_b16 v[132:133], v27 offset:61440
    ds_read_b64_tr_b16 v[134:135], v27 offset:62464
    v_mul_f32 v238, v238, v51
    v_mul_f32 v239, v239, v51
    v_cvt_pk_bf16_f32 v32, v204, v205
    v_cvt_pk_bf16_f32 v33, v206, v207
    v_cvt_pk_bf16_f32 v34, v236, v237
    v_cvt_pk_bf16_f32 v35, v238, v239
    s_nop 1
    v_permlane32_swap_b32 v32, v34
    v_permlane32_swap_b32 v33, v35
    buffer_store_dwordx4 v[32:35], v15, s[24:27], s54 offen sc1
    s_add_u32 s54, s54, 32768
    v_mfma_f32_32x32x16_bf16 v[160:175], v[104:107], v[96:99], v[160:175]
    ds_read_b64_tr_b16 v[136:137], v28 offset:61440
    ds_read_b64_tr_b16 v[138:139], v28 offset:62464
    ds_read_b64_tr_b16 v[140:141], v29 offset:61440
    v_mul_f32 v208, v208, v50
    v_mul_f32 v209, v209, v50
    v_mul_f32 v210, v210, v50
    v_mul_f32 v211, v211, v50
    v_mul_f32 v240, v240, v51
    v_mul_f32 v241, v241, v51
    v_mul_f32 v242, v242, v51
    v_mul_f32 v243, v243, v51
    v_cvt_pk_bf16_f32 v36, v208, v209
    v_cvt_pk_bf16_f32 v37, v210, v211
    v_cvt_pk_bf16_f32 v38, v240, v241
    v_cvt_pk_bf16_f32 v39, v242, v243
    s_nop 1
    v_permlane32_swap_b32 v36, v38
    v_mfma_f32_32x32x16_bf16 v[176:191], v[108:111], v[96:99], v[176:191]
    ds_read_b64_tr_b16 v[142:143], v29 offset:62464
    v_permlane32_swap_b32 v37, v39
    buffer_store_dwordx4 v[36:39], v11, s[24:27], s54 offen sc1
    s_add_u32 s54, s54, 32768
    v_mul_f32 v212, v212, v50
    v_mul_f32 v213, v213, v50
    v_mul_f32 v214, v214, v50
    v_mul_f32 v215, v215, v50
    v_mul_f32 v244, v244, v51
    v_mul_f32 v245, v245, v51
    v_mul_f32 v246, v246, v51
    v_mul_f32 v247, v247, v51
    v_cvt_pk_bf16_f32 v40, v212, v213
    v_cvt_pk_bf16_f32 v41, v214, v215
    v_cvt_pk_bf16_f32 v42, v244, v245
    v_cvt_pk_bf16_f32 v43, v246, v247
    s_waitcnt lgkmcnt(7)
    v_mfma_f32_32x32x16_bf16 v[144:159], v[116:119], v[112:115], v[144:159]
    s_nop 1
    v_permlane32_swap_b32 v40, v42
    v_permlane32_swap_b32 v41, v43
    buffer_store_dwordx4 v[40:43], v12, s[24:27], s54 offen sc1
    s_add_u32 s54, s54, 32768
    v_mul_f32 v216, v216, v50
    v_mul_f32 v217, v217, v50
    v_mul_f32 v218, v218, v50
    v_mul_f32 v219, v219, v50
    v_mul_f32 v248, v248, v51
    v_mul_f32 v249, v249, v51
    v_mul_f32 v250, v250, v51
    s_waitcnt lgkmcnt(0)
    s_barrier
    v_mfma_f32_32x32x16_bf16 v[160:175], v[120:123], v[112:115], v[160:175]
    ds_read_b128 v[80:83], v16 offset:32768
    ds_read_b64_tr_b16 v[84:85], v24 offset:0
    ds_read_b64_tr_b16 v[86:87], v24 offset:1024
    ds_read_b64_tr_b16 v[88:89], v25 offset:0
    v_mul_f32 v251, v251, v51
    v_cvt_pk_bf16_f32 v32, v216, v217
    v_cvt_pk_bf16_f32 v33, v218, v219
    v_cvt_pk_bf16_f32 v34, v248, v249
    v_cvt_pk_bf16_f32 v35, v250, v251
    s_nop 1
    v_permlane32_swap_b32 v32, v34
    v_permlane32_swap_b32 v33, v35
    buffer_store_dwordx4 v[32:35], v13, s[24:27], s54 offen sc1
    s_add_u32 s54, s54, 32768
    v_mfma_f32_32x32x16_bf16 v[176:191], v[124:127], v[112:115], v[176:191]
    ds_read_b64_tr_b16 v[90:91], v25 offset:1024
    ds_read_b64_tr_b16 v[92:93], v26 offset:0
    ds_read_b64_tr_b16 v[94:95], v26 offset:1024
    v_mul_f32 v220, v220, v50
    v_mul_f32 v221, v221, v50
    v_mul_f32 v222, v222, v50
    v_mul_f32 v223, v223, v50
    v_mul_f32 v252, v252, v51
    v_mul_f32 v253, v253, v51
    v_mul_f32 v254, v254, v51
    v_mul_f32 v255, v255, v51
    v_cvt_pk_bf16_f32 v36, v220, v221
    v_cvt_pk_bf16_f32 v37, v222, v223
    v_cvt_pk_bf16_f32 v38, v252, v253
    v_cvt_pk_bf16_f32 v39, v254, v255
    s_nop 1
    v_permlane32_swap_b32 v36, v38
    s_cbranch_vccz P1C_nc11_2
    v_mfma_f32_16x16x32_bf16 v[60:63], v[44:47], v[116:119], v[60:63]
    v_mfma_f32_16x16x32_bf16 v[64:67], v[44:47], v[120:123], v[64:67]
    v_mfma_f32_16x16x32_bf16 v[68:71], v[44:47], v[124:127], v[68:71]
P1C_nc11_2:
    v_mfma_f32_32x32x16_bf16 v[144:159], v[132:135], v[128:131], v[144:159]
    ds_read_b128 v[96:99], v17 offset:32768
    ds_read_b64_tr_b16 v[100:101], v27 offset:4096
    ds_read_b64_tr_b16 v[102:103], v27 offset:5120
    v_permlane32_swap_b32 v37, v39
    buffer_store_dwordx4 v[36:39], v14, s[24:27], s54 offen sc1
    s_add_u32 s54, s54, 32768
    v_mul_f32 v56, 0x3acccccd, v56
    v_mul_f32 v57, 0x3acccccd, v57
    v_fma_f32 v57, -v56, v56, v57
    v_max_f32 v57, 0, v57
    v_cvt_pk_bf16_f32 v57, v57, v57
    v_and_b32 v57, 0xffff0000, v57
    v_add_f32 v57, 0x3727c5ac, v57
    v_cvt_pk_bf16_f32 v57, v57, v57
    v_mfma_f32_32x32x16_bf16 v[160:175], v[136:139], v[128:131], v[160:175]
    ds_read_b64_tr_b16 v[104:105], v28 offset:4096
    ds_read_b64_tr_b16 v[106:107], v28 offset:5120
    ds_read_b64_tr_b16 v[108:109], v29 offset:4096
    v_and_b32 v57, 0xffff0000, v57
    v_sqrt_f32 v57, v57
    v_cvt_pk_bf16_f32 v56, -v56, -v56
    v_cvt_pk_bf16_f32 v57, v57, v57
    v_and_b32 v57, 0xffff0000, v57
    v_rcp_f32 v52, v57
    v_cndmask_b32 v58, 0, v56, s[60:61]
    v_and_b32 v59, 0xffff, v58
    v_mul_f32 v48, 0xc0135761, v52
    v_mul_f32 v50, v52, v52
    v_mul_f32 v50, v50, v52
    v_mul_f32 v50, 0xbdd2d3e8, v50
    v_mov_b32 v54, v57
    v_mfma_f32_32x32x16_bf16 v[176:191], v[140:143], v[128:131], v[176:191]
    ds_read_b64_tr_b16 v[110:111], v29 offset:5120
    s_waitcnt lgkmcnt(7)
    v_mfma_f32_32x32x16_bf16 v[144:159], v[84:87], v[80:83], v[144:159]
    ds_read_b128 v[112:115], v18 offset:32768
    ds_read_b64_tr_b16 v[116:117], v24 offset:8192
    ds_read_b64_tr_b16 v[118:119], v24 offset:9216
    v_mfma_f32_32x32x16_bf16 v[160:175], v[88:91], v[80:83], v[160:175]
    ds_read_b64_tr_b16 v[120:121], v25 offset:8192
    ds_read_b64_tr_b16 v[122:123], v25 offset:9216
    ds_read_b64_tr_b16 v[124:125], v26 offset:8192
    v_mfma_f32_32x32x16_bf16 v[176:191], v[92:95], v[80:83], v[176:191]
    ds_read_b64_tr_b16 v[126:127], v26 offset:9216
    s_cbranch_vccnz P1C_nc12_0
    v_mfma_f32_16x16x32_bf16 v[60:63], v[44:47], v[84:87], v[60:63]
    v_mfma_f32_16x16x32_bf16 v[64:67], v[44:47], v[88:91], v[64:67]
    v_mfma_f32_16x16x32_bf16 v[68:71], v[44:47], v[92:95], v[68:71]
P1C_nc12_0:
    s_waitcnt lgkmcnt(7)
    v_mfma_f32_32x32x16_bf16 v[144:159], v[100:103], v[96:99], v[144:159]
    ds_read_b128 v[128:131], v19 offset:32768
    ds_read_b64_tr_b16 v[132:133], v27 offset:12288
    ds_read_b64_tr_b16 v[134:135], v27 offset:13312
    v_mfma_f32_32x32x16_bf16 v[160:175], v[104:107], v[96:99], v[160:175]
    ds_read_b64_tr_b16 v[136:137], v28 offset:12288
    ds_read_b64_tr_b16 v[138:139], v28 offset:13312
    ds_read_b64_tr_b16 v[140:141], v29 offset:12288
    v_mfma_f32_32x32x16_bf16 v[176:191], v[108:111], v[96:99], v[176:191]
    ds_read_b64_tr_b16 v[142:143], v29 offset:13312
    s_waitcnt lgkmcnt(7)
    v_mfma_f32_32x32x16_bf16 v[144:159], v[116:119], v[112:115], v[144:159]
    s_waitcnt lgkmcnt(0)
    s_barrier
    v_mfma_f32_32x32x16_bf16 v[160:175], v[120:123], v[112:115], v[160:175]
    ds_read_b128 v[80:83], v16 offset:16384
    ds_read_b64_tr_b16 v[84:85], v24 offset:16384
    ds_read_b64_tr_b16 v[86:87], v24 offset:17408
    ds_read_b64_tr_b16 v[88:89], v25 offset:16384
    v_mfma_f32_32x32x16_bf16 v[176:191], v[124:127], v[112:115], v[176:191]
    ds_read_b64_tr_b16 v[90:91], v25 offset:17408
    ds_read_b64_tr_b16 v[92:93], v26 offset:16384
    ds_read_b64_tr_b16 v[94:95], v26 offset:17408
    s_cbranch_vccz P1C_nc12_2
    v_mfma_f32_16x16x32_bf16 v[60:63], v[44:47], v[116:119], v[60:63]
    v_mfma_f32_16x16x32_bf16 v[64:67], v[44:47], v[120:123], v[64:67]
    v_mfma_f32_16x16x32_bf16 v[68:71], v[44:47], v[124:127], v[68:71]
P1C_nc12_2:
    v_mfma_f32_32x32x16_bf16 v[144:159], v[132:135], v[128:131], v[144:159]
    ds_read_b128 v[96:99], v17 offset:16384
    ds_read_b64_tr_b16 v[100:101], v27 offset:20480
    ds_read_b64_tr_b16 v[102:103], v27 offset:21504
    v_mfma_f32_32x32x16_bf16 v[160:175], v[136:139], v[128:131], v[160:175]
    ds_read_b64_tr_b16 v[104:105], v28 offset:20480
    ds_read_b64_tr_b16 v[106:107], v28 offset:21504
    ds_read_b64_tr_b16 v[108:109], v29 offset:20480
    v_mfma_f32_32x32x16_bf16 v[176:191], v[140:143], v[128:131], v[176:191]
    ds_read_b64_tr_b16 v[110:111], v29 offset:21504
    s_waitcnt lgkmcnt(7)
    v_mfma_f32_32x32x16_bf16 v[144:159], v[84:87], v[80:83], v[144:159]
    ds_read_b128 v[112:115], v18 offset:16384
    ds_read_b64_tr_b16 v[116:117], v24 offset:24576
    ds_read_b64_tr_b16 v[118:119], v24 offset:25600
    v_mfma_f32_32x32x16_bf16 v[160:175], v[88:91], v[80:83], v[160:175]
    ds_read_b64_tr_b16 v[120:121], v25 offset:24576
    ds_read_b64_tr_b16 v[122:123], v25 offset:25600
    ds_read_b64_tr_b16 v[124:125], v26 offset:24576
    v_mfma_f32_32x32x16_bf16 v[176:191], v[92:95], v[80:83], v[176:191]
    ds_read_b64_tr_b16 v[126:127], v26 offset:25600
    s_cbranch_vccnz P1C_nc13_0
    v_mfma_f32_16x16x32_bf16 v[60:63], v[44:47], v[84:87], v[60:63]
    v_mfma_f32_16x16x32_bf16 v[64:67], v[44:47], v[88:91], v[64:67]
    v_mfma_f32_16x16x32_bf16 v[68:71], v[44:47], v[92:95], v[68:71]
P1C_nc13_0:
    s_waitcnt lgkmcnt(7)
    v_mfma_f32_32x32x16_bf16 v[144:159], v[100:103], v[96:99], v[144:159]
    ds_read_b128 v[128:131], v19 offset:16384
    ds_read_b64_tr_b16 v[132:133], v27 offset:28672
    ds_read_b64_tr_b16 v[134:135], v27 offset:29696
    v_mfma_f32_32x32x16_bf16 v[160:175], v[104:107], v[96:99], v[160:175]
    ds_read_b64_tr_b16 v[136:137], v28 offset:28672
    ds_read_b64_tr_b16 v[138:139], v28 offset:29696
    ds_read_b64_tr_b16 v[140:141], v29 offset:28672
    v_mfma_f32_32x32x16_bf16 v[176:191], v[108:111], v[96:99], v[176:191]
    ds_read_b64_tr_b16 v[142:143], v29 offset:29696
    s_waitcnt lgkmcnt(7)
    v_mfma_f32_32x32x16_bf16 v[144:159], v[116:119], v[112:115], v[144:159]
    s_waitcnt lgkmcnt(0)
    s_barrier
    v_mfma_f32_32x32x16_bf16 v[160:175], v[120:123], v[112:115], v[160:175]
    ds_read_b128 v[80:83], v16 offset:0
    ds_read_b64_tr_b16 v[84:85], v24 offset:32768
    ds_read_b64_tr_b16 v[86:87], v24 offset:33792
    ds_read_b64_tr_b16 v[88:89], v25 offset:32768
    v_mov_b32 v9, s3
    v_mov_b32 v10, 0
    s_mov_b64 exec, 1
    s_waitcnt vmcnt(0)
    buffer_store_dword v9, v10, s[24:27], s57 offen sc1
    s_mov_b64 exec, -1
    v_mfma_f32_32x32x16_bf16 v[176:191], v[124:127], v[112:115], v[176:191]
    ds_read_b64_tr_b16 v[90:91], v25 offset:33792
    ds_read_b64_tr_b16 v[92:93], v26 offset:32768
    ds_read_b64_tr_b16 v[94:95], v26 offset:33792
    s_lshr_b32 s64, s12, 1
    s_mul_i32 s64, s64, 6144
    s_movk_i32 s65, 12288
    v_lshlrev_b32 v32, 2, v4
    s_cbranch_vccz P1C_nc13_2
    v_mfma_f32_16x16x32_bf16 v[60:63], v[44:47], v[116:119], v[60:63]
    v_mfma_f32_16x16x32_bf16 v[64:67], v[44:47], v[120:123], v[64:67]
    v_mfma_f32_16x16x32_bf16 v[68:71], v[44:47], v[124:127], v[68:71]
P1C_nc13_2:
    v_mfma_f32_32x32x16_bf16 v[144:159], v[132:135], v[128:131], v[144:159]
    ds_read_b128 v[96:99], v17 offset:0
    ds_read_b64_tr_b16 v[100:101], v27 offset:36864
    ds_read_b64_tr_b16 v[102:103], v27 offset:37888
    v_xor_b32 v32, v32, v3
    v_lshlrev_b32 v32, 4, v32
    v_lshl_add_u32 v12, v4, 10, v32
    v_add_u32 v12, s64, v12
    v_mfma_f32_32x32x16_bf16 v[160:175], v[136:139], v[128:131], v[160:175]
    ds_read_b64_tr_b16 v[104:105], v28 offset:36864
    ds_read_b64_tr_b16 v[106:107], v28 offset:37888
    ds_read_b64_tr_b16 v[108:109], v29 offset:36864
    v_xor_b32 v32, 8, v3
    s_lshl_b32 s70, s32, 3
    s_add_u32 s70, s70, s64
    s_add_u32 s70, s70, 2048
    v_mfma_f32_32x32x16_bf16 v[176:191], v[140:143], v[128:131], v[176:191]
    ds_read_b64_tr_b16 v[110:111], v29 offset:37888
    v_lshl_add_u32 v32, v32, 4, s70
    v_lshl_add_u32 v33, v3, 4, s65
    s_mov_b32 s66, -1
    s_mov_b32 s67, 0
    s_waitcnt lgkmcnt(7)
    v_mfma_f32_32x32x16_bf16 v[144:159], v[84:87], v[80:83], v[144:159]
    ds_read_b128 v[112:115], v18 offset:0
    ds_read_b64_tr_b16 v[116:117], v24 offset:40960
    ds_read_b64_tr_b16 v[118:119], v24 offset:41984
    v_cndmask_b32 v13, v33, v32, s[66:67]
    v_bfe_u32 v34, v2, 2, 2
    v_lshl_add_u32 v34, v4, 2, v34
    v_bfe_u32 v32, v2, 4, 1
    v_mfma_f32_32x32x16_bf16 v[160:175], v[88:91], v[80:83], v[160:175]
    ds_read_b64_tr_b16 v[120:121], v25 offset:40960
    ds_read_b64_tr_b16 v[122:123], v25 offset:41984
    ds_read_b64_tr_b16 v[124:125], v26 offset:40960
    v_bfe_u32 v33, v2, 1, 1
    v_lshl_add_u32 v32, v32, 1, v33
    s_mov_b32 s66, 0xeeee0000
    s_mov_b32 s67, 0xeeee0000
    v_mfma_f32_32x32x16_bf16 v[176:191], v[92:95], v[80:83], v[176:191]
    ds_read_b64_tr_b16 v[126:127], v26 offset:41984
    v_cndmask_b32 v32, v32, 3, s[66:67]
    v_and_b32 v35, 1, v2
    v_cndmask_b32 v35, v35, v33, s[66:67]
    s_mul_i32 s68, s32, 0x11110000
    s_cbranch_vccnz P1C_nc14_0
    v_mfma_f32_16x16x32_bf16 v[60:63], v[44:47], v[84:87], v[60:63]
    v_mfma_f32_16x16x32_bf16 v[64:67], v[44:47], v[88:91], v[64:67]
    v_mfma_f32_16x16x32_bf16 v[68:71], v[44:47], v[92:95], v[68:71]
P1C_nc14_0:
    s_waitcnt lgkmcnt(7)
    v_mfma_f32_32x32x16_bf16 v[144:159], v[100:103], v[96:99], v[144:159]
    ds_read_b128 v[128:131], v19 offset:0
    ds_read_b64_tr_b16 v[132:133], v27 offset:45056
    ds_read_b64_tr_b16 v[134:135], v27 offset:46080
    s_mov_b32 s69, s68
    v_cndmask_b32 v35, v35, 1, s[68:69]
    v_lshlrev_b32 v33, 2, v32
    v_xor_b32 v33, v33, v34
    v_mfma_f32_32x32x16_bf16 v[160:175], v[104:107], v[96:99], v[160:175]
    ds_read_b64_tr_b16 v[136:137], v28 offset:45056
    ds_read_b64_tr_b16 v[138:139], v28 offset:46080
    ds_read_b64_tr_b16 v[140:141], v29 offset:45056
    v_lshlrev_b32 v33, 4, v33
    v_lshl_add_u32 v33, v35, 3, v33
    s_add_u32 s70, s64, 3072
    v_lshl_add_u32 v32, v32, 10, s70
    v_mfma_f32_32x32x16_bf16 v[176:191], v[108:111], v[96:99], v[176:191]
    ds_read_b64_tr_b16 v[142:143], v29 offset:46080
    v_mov_b32 v35, s65
    v_cndmask_b32 v32, v32, v35, s[66:67]
    v_add_u32 v14, v33, v32
    v_xor_b32 v15, 0x80, v14
    s_waitcnt lgkmcnt(7)
    v_mfma_f32_32x32x16_bf16 v[144:159], v[116:119], v[112:115], v[144:159]
    v_mov_b32 v192, 0
    v_mov_b32 v193, 0
    v_mov_b32 v194, 0
    v_mov_b32 v195, 0
    s_waitcnt lgkmcnt(0)
    s_barrier
    v_mfma_f32_32x32x16_bf16 v[160:175], v[120:123], v[112:115], v[160:175]
    ds_read_b128 v[80:83], v20 offset:0
    ds_read_b64_tr_b16 v[84:85], v24 offset:49152
    ds_read_b64_tr_b16 v[86:87], v24 offset:50176
    ds_read_b64_tr_b16 v[88:89], v25 offset:49152
    v_mov_b32 v196, 0
    v_mov_b32 v197, 0
    v_mov_b32 v198, 0
    v_mov_b32 v199, 0
    v_mfma_f32_32x32x16_bf16 v[176:191], v[124:127], v[112:115], v[176:191]
    ds_read_b64_tr_b16 v[90:91], v25 offset:50176
    ds_read_b64_tr_b16 v[92:93], v26 offset:49152
    ds_read_b64_tr_b16 v[94:95], v26 offset:50176
    v_mov_b32 v200, 0
    v_mov_b32 v201, 0
    v_mov_b32 v202, 0
    v_mov_b32 v203, 0
    s_cbranch_vccz P1C_nc14_2
    v_mfma_f32_16x16x32_bf16 v[60:63], v[44:47], v[116:119], v[60:63]
    v_mfma_f32_16x16x32_bf16 v[64:67], v[44:47], v[120:123], v[64:67]
    v_mfma_f32_16x16x32_bf16 v[68:71], v[44:47], v[124:127], v[68:71]
P1C_nc14_2:
    v_mfma_f32_32x32x16_bf16 v[144:159], v[132:135], v[128:131], v[144:159]
    ds_read_b128 v[96:99], v21 offset:0
    ds_read_b64_tr_b16 v[100:101], v27 offset:53248
    ds_read_b64_tr_b16 v[102:103], v27 offset:54272
    v_mov_b32 v204, 0
    v_mov_b32 v205, 0
    v_mov_b32 v206, 0
    v_mov_b32 v207, 0
    v_mfma_f32_32x32x16_bf16 v[160:175], v[136:139], v[128:131], v[160:175]
    ds_read_b64_tr_b16 v[104:105], v28 offset:53248
    ds_read_b64_tr_b16 v[106:107], v28 offset:54272
    ds_read_b64_tr_b16 v[108:109], v29 offset:53248
    v_mov_b32 v208, 0
    v_mov_b32 v209, 0
    v_mov_b32 v210, 0
    v_mov_b32 v211, 0
    v_mfma_f32_32x32x16_bf16 v[176:191], v[140:143], v[128:131], v[176:191]
    ds_read_b64_tr_b16 v[110:111], v29 offset:54272
    v_mov_b32 v212, 0
    v_mov_b32 v213, 0
    v_mov_b32 v214, 0
    v_mov_b32 v215, 0
    s_waitcnt lgkmcnt(7)
    v_mfma_f32_32x32x16_bf16 v[144:159], v[84:87], v[80:83], v[144:159]
    ds_read_b128 v[112:115], v22 offset:0
    ds_read_b64_tr_b16 v[116:117], v24 offset:57344
    ds_read_b64_tr_b16 v[118:119], v24 offset:58368
    v_mov_b32 v216, 0
    v_mov_b32 v217, 0
    v_mov_b32 v218, 0
    v_mov_b32 v219, 0
    v_mfma_f32_32x32x16_bf16 v[160:175], v[88:91], v[80:83], v[160:175]
    ds_read_b64_tr_b16 v[120:121], v25 offset:57344
    ds_read_b64_tr_b16 v[122:123], v25 offset:58368
    ds_read_b64_tr_b16 v[124:125], v26 offset:57344
    v_mov_b32 v220, 0
    v_mov_b32 v221, 0
    v_mov_b32 v222, 0
    v_mov_b32 v223, 0
    v_mfma_f32_32x32x16_bf16 v[176:191], v[92:95], v[80:83], v[176:191]
    ds_read_b64_tr_b16 v[126:127], v26 offset:58368
    v_mov_b32 v224, 0
    v_mov_b32 v225, 0
    v_mov_b32 v226, 0
    v_mov_b32 v227, 0
    s_cbranch_vccnz P1C_nc15_0
    v_mfma_f32_16x16x32_bf16 v[60:63], v[44:47], v[84:87], v[60:63]
    v_mfma_f32_16x16x32_bf16 v[64:67], v[44:47], v[88:91], v[64:67]
    v_mfma_f32_16x16x32_bf16 v[68:71], v[44:47], v[92:95], v[68:71]
P1C_nc15_0:
    s_waitcnt lgkmcnt(7)
    v_mfma_f32_32x32x16_bf16 v[144:159], v[100:103], v[96:99], v[144:159]
    ds_read_b128 v[128:131], v23 offset:0
    ds_read_b64_tr_b16 v[132:133], v27 offset:61440
    ds_read_b64_tr_b16 v[134:135], v27 offset:62464
    v_mov_b32 v228, 0
    v_mov_b32 v229, 0
    v_mov_b32 v230, 0
    v_mov_b32 v231, 0
    v_mfma_f32_32x32x16_bf16 v[160:175], v[104:107], v[96:99], v[160:175]
    ds_read_b64_tr_b16 v[136:137], v28 offset:61440
    ds_read_b64_tr_b16 v[138:139], v28 offset:62464
    ds_read_b64_tr_b16 v[140:141], v29 offset:61440
    v_mov_b32 v232, 0
    v_mov_b32 v233, 0
    v_mov_b32 v234, 0
    v_mov_b32 v235, 0
    v_mfma_f32_32x32x16_bf16 v[176:191], v[108:111], v[96:99], v[176:191]
    ds_read_b64_tr_b16 v[142:143], v29 offset:62464
    v_mov_b32 v236, 0
    v_mov_b32 v237, 0
    v_mov_b32 v238, 0
    v_mov_b32 v239, 0
    s_waitcnt lgkmcnt(7)
    v_mfma_f32_32x32x16_bf16 v[144:159], v[116:119], v[112:115], v[144:159]
    v_mov_b32 v240, 0
    v_mov_b32 v241, 0
    v_mov_b32 v242, 0
    v_mov_b32 v243, 0
    s_waitcnt lgkmcnt(0)
    s_barrier
    v_mfma_f32_32x32x16_bf16 v[160:175], v[120:123], v[112:115], v[160:175]
    ds_read_b128 v[80:83], v16 offset:49152
    ds_read_b64_tr_b16 v[84:85], v24 offset:0
    ds_read_b64_tr_b16 v[86:87], v24 offset:1024
    ds_read_b64_tr_b16 v[88:89], v25 offset:0
    v_mov_b32 v244, 0
    v_mov_b32 v245, 0
    v_mov_b32 v246, 0
    v_mov_b32 v247, 0
    v_mfma_f32_32x32x16_bf16 v[176:191], v[124:127], v[112:115], v[176:191]
    ds_read_b64_tr_b16 v[90:91], v25 offset:1024
    ds_read_b64_tr_b16 v[92:93], v26 offset:0
    ds_read_b64_tr_b16 v[94:95], v26 offset:1024
    v_mov_b32 v248, 0
    v_mov_b32 v249, 0
    v_mov_b32 v250, 0
    v_mov_b32 v251, 0
    s_cbranch_vccz P1C_nc15_2
    v_mfma_f32_16x16x32_bf16 v[60:63], v[44:47], v[116:119], v[60:63]
    v_mfma_f32_16x16x32_bf16 v[64:67], v[44:47], v[120:123], v[64:67]
    v_mfma_f32_16x16x32_bf16 v[68:71], v[44:47], v[124:127], v[68:71]
P1C_nc15_2:
    v_mfma_f32_32x32x16_bf16 v[144:159], v[132:135], v[128:131], v[144:159]
    ds_read_b128 v[96:99], v17 offset:49152
    ds_read_b64_tr_b16 v[100:101], v27 offset:4096
    ds_read_b64_tr_b16 v[102:103], v27 offset:5120
    v_mov_b32 v252, 0
    v_mov_b32 v253, 0
    v_mov_b32 v254, 0
    v_mov_b32 v255, 0
    v_mfma_f32_32x32x16_bf16 v[160:175], v[136:139], v[128:131], v[160:175]
    ds_read_b64_tr_b16 v[104:105], v28 offset:4096
    ds_read_b64_tr_b16 v[106:107], v28 offset:5120
    ds_read_b64_tr_b16 v[108:109], v29 offset:4096
    s_lshl_b32 s76, s14, 2
    s_and_b32 s77, s12, 1
    s_lshl_b32 s77, s77, 1
    s_add_u32 s76, s76, s77
    v_mfma_f32_32x32x16_bf16 v[176:191], v[140:143], v[128:131], v[176:191]
    ds_read_b64_tr_b16 v[110:111], v29 offset:5120
    s_lshr_b32 s77, s12, 1
    s_add_u32 s76, s76, s77
    s_xor_b32 s76, s76, 1
    s_mul_i32 s77, s76, 176
    s_waitcnt lgkmcnt(7)
    v_mfma_f32_32x32x16_bf16 v[144:159], v[84:87], v[80:83], v[144:159]
    ds_read_b128 v[112:115], v18 offset:49152
    ds_read_b64_tr_b16 v[116:117], v24 offset:8192
    ds_read_b64_tr_b16 v[118:119], v24 offset:9216
    s_lshr_b32 s78, s13, 1
    s_add_u32 s77, s77, s78
    s_lshl_b32 s77, s77, 10
    s_lshl_b32 s78, s32, 9
    v_mfma_f32_32x32x16_bf16 v[160:175], v[88:91], v[80:83], v[160:175]
    ds_read_b64_tr_b16 v[120:121], v25 offset:8192
    ds_read_b64_tr_b16 v[122:123], v25 offset:9216
    ds_read_b64_tr_b16 v[124:125], v26 offset:8192
    s_add_u32 s77, s77, s78
    s_add_u32 s77, s77, 18874368
    s_lshl_b32 s78, s76, 5
    s_add_u32 s78, s78, s13
    v_mfma_f32_32x32x16_bf16 v[176:191], v[92:95], v[80:83], v[176:191]
    ds_read_b64_tr_b16 v[126:127], v26 offset:9216
    s_lshl_b32 s78, s78, 9
    s_add_u32 s78, s78, 24641536
    s_lshl_b32 s76, s76, 2
    s_lshr_b32 s73, s13, 3
    s_cbranch_vccnz P1C_nc16_0
    v_mfma_f32_16x16x32_bf16 v[60:63], v[44:47], v[84:87], v[60:63]
    v_mfma_f32_16x16x32_bf16 v[64:67], v[44:47], v[88:91], v[64:67]
    v_mfma_f32_16x16x32_bf16 v[68:71], v[44:47], v[92:95], v[68:71]
P1C_nc16_0:
    s_waitcnt lgkmcnt(7)
    v_mfma_f32_32x32x16_bf16 v[144:159], v[100:103], v[96:99], v[144:159]
    ds_read_b128 v[128:131], v19 offset:49152
    ds_read_b64_tr_b16 v[132:133], v27 offset:12288
    ds_read_b64_tr_b16 v[134:135], v27 offset:13312
    s_add_u32 s76, s76, s73
    s_lshl_b32 s76, s76, 5
    s_and_b32 s73, s13, 7
    s_add_u32 s76, s76, s73
    v_mfma_f32_32x32x16_bf16 v[160:175], v[104:107], v[96:99], v[160:175]
    ds_read_b64_tr_b16 v[136:137], v28 offset:12288
    ds_read_b64_tr_b16 v[138:139], v28 offset:13312
    ds_read_b64_tr_b16 v[140:141], v29 offset:12288
    s_lshl_b32 s76, s76, 2
    s_add_u32 s76, s76, 27246592
    v_mfma_f32_32x32x16_bf16 v[176:191], v[108:111], v[96:99], v[176:191]
    ds_read_b64_tr_b16 v[142:143], v29 offset:13312
    s_waitcnt lgkmcnt(7)
    v_mfma_f32_32x32x16_bf16 v[144:159], v[116:119], v[112:115], v[144:159]
    s_waitcnt lgkmcnt(0)
    s_barrier
    v_mfma_f32_32x32x16_bf16 v[160:175], v[120:123], v[112:115], v[160:175]
    ds_read_b128 v[80:83], v16 offset:32768
    ds_read_b64_tr_b16 v[84:85], v24 offset:16384
    ds_read_b64_tr_b16 v[86:87], v24 offset:17408
    ds_read_b64_tr_b16 v[88:89], v25 offset:16384
    v_mfma_f32_32x32x16_bf16 v[176:191], v[124:127], v[112:115], v[176:191]
    ds_read_b64_tr_b16 v[90:91], v25 offset:17408
    ds_read_b64_tr_b16 v[92:93], v26 offset:16384
    ds_read_b64_tr_b16 v[94:95], v26 offset:17408
    s_cbranch_vccz P1C_nc16_2
    v_mfma_f32_16x16x32_bf16 v[60:63], v[44:47], v[116:119], v[60:63]
    v_mfma_f32_16x16x32_bf16 v[64:67], v[44:47], v[120:123], v[64:67]
    v_mfma_f32_16x16x32_bf16 v[68:71], v[44:47], v[124:127], v[68:71]
P1C_nc16_2:
    v_mfma_f32_32x32x16_bf16 v[144:159], v[132:135], v[128:131], v[144:159]
    ds_read_b128 v[96:99], v17 offset:32768
    ds_read_b64_tr_b16 v[100:101], v27 offset:20480
    ds_read_b64_tr_b16 v[102:103], v27 offset:21504
    v_mfma_f32_32x32x16_bf16 v[160:175], v[136:139], v[128:131], v[160:175]
    ds_read_b64_tr_b16 v[104:105], v28 offset:20480
    ds_read_b64_tr_b16 v[106:107], v28 offset:21504
    ds_read_b64_tr_b16 v[108:109], v29 offset:20480
    v_mfma_f32_32x32x16_bf16 v[176:191], v[140:143], v[128:131], v[176:191]
    ds_read_b64_tr_b16 v[110:111], v29 offset:21504
    s_waitcnt lgkmcnt(7)
    v_mfma_f32_32x32x16_bf16 v[144:159], v[84:87], v[80:83], v[144:159]
    ds_read_b128 v[112:115], v18 offset:32768
    ds_read_b64_tr_b16 v[116:117], v24 offset:24576
    ds_read_b64_tr_b16 v[118:119], v24 offset:25600
    v_mfma_f32_32x32x16_bf16 v[160:175], v[88:91], v[80:83], v[160:175]
    ds_read_b64_tr_b16 v[120:121], v25 offset:24576
    ds_read_b64_tr_b16 v[122:123], v25 offset:25600
    ds_read_b64_tr_b16 v[124:125], v26 offset:24576
    v_mfma_f32_32x32x16_bf16 v[176:191], v[92:95], v[80:83], v[176:191]
    ds_read_b64_tr_b16 v[126:127], v26 offset:25600
    s_cbranch_vccnz P1C_nc17_0
    v_mfma_f32_16x16x32_bf16 v[60:63], v[44:47], v[84:87], v[60:63]
    v_mfma_f32_16x16x32_bf16 v[64:67], v[44:47], v[88:91], v[64:67]
    v_mfma_f32_16x16x32_bf16 v[68:71], v[44:47], v[92:95], v[68:71]
P1C_nc17_0:
    s_waitcnt lgkmcnt(7)
    v_mfma_f32_32x32x16_bf16 v[144:159], v[100:103], v[96:99], v[144:159]
    ds_read_b128 v[128:131], v19 offset:32768
    ds_read_b64_tr_b16 v[132:133], v27 offset:28672
    ds_read_b64_tr_b16 v[134:135], v27 offset:29696
    v_mfma_f32_32x32x16_bf16 v[160:175], v[104:107], v[96:99], v[160:175]
    ds_read_b64_tr_b16 v[136:137], v28 offset:28672
    ds_read_b64_tr_b16 v[138:139], v28 offset:29696
    ds_read_b64_tr_b16 v[140:141], v29 offset:28672
    v_mfma_f32_32x32x16_bf16 v[176:191], v[108:111], v[96:99], v[176:191]
    ds_read_b64_tr_b16 v[142:143], v29 offset:29696
    s_waitcnt lgkmcnt(7)
    v_mfma_f32_32x32x16_bf16 v[144:159], v[116:119], v[112:115], v[144:159]
    s_waitcnt lgkmcnt(0)
    s_barrier
    v_mfma_f32_32x32x16_bf16 v[160:175], v[120:123], v[112:115], v[160:175]
    ds_read_b128 v[80:83], v16 offset:16384
    ds_read_b64_tr_b16 v[84:85], v24 offset:32768
    ds_read_b64_tr_b16 v[86:87], v24 offset:33792
    ds_read_b64_tr_b16 v[88:89], v25 offset:32768
    v_mfma_f32_32x32x16_bf16 v[176:191], v[124:127], v[112:115], v[176:191]
    ds_read_b64_tr_b16 v[90:91], v25 offset:33792
    ds_read_b64_tr_b16 v[92:93], v26 offset:32768
    ds_read_b64_tr_b16 v[94:95], v26 offset:33792
    s_cbranch_vccz P1C_nc17_2
    v_mfma_f32_16x16x32_bf16 v[60:63], v[44:47], v[116:119], v[60:63]
    v_mfma_f32_16x16x32_bf16 v[64:67], v[44:47], v[120:123], v[64:67]
    v_mfma_f32_16x16x32_bf16 v[68:71], v[44:47], v[124:127], v[68:71]
P1C_nc17_2:
    v_mfma_f32_32x32x16_bf16 v[144:159], v[132:135], v[128:131], v[144:159]
    ds_read_b128 v[96:99], v17 offset:16384
    ds_read_b64_tr_b16 v[100:101], v27 offset:36864
    ds_read_b64_tr_b16 v[102:103], v27 offset:37888
    v_mfma_f32_32x32x16_bf16 v[160:175], v[136:139], v[128:131], v[160:175]
    ds_read_b64_tr_b16 v[104:105], v28 offset:36864
    ds_read_b64_tr_b16 v[106:107], v28 offset:37888
    ds_read_b64_tr_b16 v[108:109], v29 offset:36864
    v_mfma_f32_32x32x16_bf16 v[176:191], v[140:143], v[128:131], v[176:191]
    ds_read_b64_tr_b16 v[110:111], v29 offset:37888
    s_waitcnt lgkmcnt(7)
    v_mfma_f32_32x32x16_bf16 v[144:159], v[84:87], v[80:83], v[144:159]
    ds_read_b128 v[112:115], v18 offset:16384
    ds_read_b64_tr_b16 v[116:117], v24 offset:40960
    ds_read_b64_tr_b16 v[118:119], v24 offset:41984
    v_mfma_f32_32x32x16_bf16 v[160:175], v[88:91], v[80:83], v[160:175]
    ds_read_b64_tr_b16 v[120:121], v25 offset:40960
    ds_read_b64_tr_b16 v[122:123], v25 offset:41984
    ds_read_b64_tr_b16 v[124:125], v26 offset:40960
    v_mfma_f32_32x32x16_bf16 v[176:191], v[92:95], v[80:83], v[176:191]
    ds_read_b64_tr_b16 v[126:127], v26 offset:41984
    s_cbranch_vccnz P1C_nc18_0
    v_mfma_f32_16x16x32_bf16 v[60:63], v[44:47], v[84:87], v[60:63]
    v_mfma_f32_16x16x32_bf16 v[64:67], v[44:47], v[88:91], v[64:67]
    v_mfma_f32_16x16x32_bf16 v[68:71], v[44:47], v[92:95], v[68:71]
P1C_nc18_0:
    s_waitcnt lgkmcnt(7)
    v_mfma_f32_32x32x16_bf16 v[144:159], v[100:103], v[96:99], v[144:159]
    ds_read_b128 v[128:131], v19 offset:16384
    ds_read_b64_tr_b16 v[132:133], v27 offset:45056
    ds_read_b64_tr_b16 v[134:135], v27 offset:46080
    v_mfma_f32_32x32x16_bf16 v[160:175], v[104:107], v[96:99], v[160:175]
    ds_read_b64_tr_b16 v[136:137], v28 offset:45056
    ds_read_b64_tr_b16 v[138:139], v28 offset:46080
    ds_read_b64_tr_b16 v[140:141], v29 offset:45056
    v_mfma_f32_32x32x16_bf16 v[176:191], v[108:111], v[96:99], v[176:191]
    ds_read_b64_tr_b16 v[142:143], v29 offset:46080
    s_waitcnt lgkmcnt(7)
    v_mfma_f32_32x32x16_bf16 v[144:159], v[116:119], v[112:115], v[144:159]
    s_waitcnt lgkmcnt(0)
    s_barrier
    v_mfma_f32_32x32x16_bf16 v[160:175], v[120:123], v[112:115], v[160:175]
    ds_read_b128 v[80:83], v16 offset:0
    ds_read_b64_tr_b16 v[84:85], v24 offset:49152
    ds_read_b64_tr_b16 v[86:87], v24 offset:50176
    ds_read_b64_tr_b16 v[88:89], v25 offset:49152
    v_mfma_f32_32x32x16_bf16 v[176:191], v[124:127], v[112:115], v[176:191]
    ds_read_b64_tr_b16 v[90:91], v25 offset:50176
    ds_read_b64_tr_b16 v[92:93], v26 offset:49152
    ds_read_b64_tr_b16 v[94:95], v26 offset:50176
    s_cbranch_vccz P1C_nc18_2
    v_mfma_f32_16x16x32_bf16 v[60:63], v[44:47], v[116:119], v[60:63]
    v_mfma_f32_16x16x32_bf16 v[64:67], v[44:47], v[120:123], v[64:67]
    v_mfma_f32_16x16x32_bf16 v[68:71], v[44:47], v[124:127], v[68:71]
P1C_nc18_2:
    v_mfma_f32_32x32x16_bf16 v[144:159], v[132:135], v[128:131], v[144:159]
    ds_read_b128 v[96:99], v17 offset:0
    ds_read_b64_tr_b16 v[100:101], v27 offset:53248
    ds_read_b64_tr_b16 v[102:103], v27 offset:54272
    v_mfma_f32_32x32x16_bf16 v[160:175], v[136:139], v[128:131], v[160:175]
    ds_read_b64_tr_b16 v[104:105], v28 offset:53248
    ds_read_b64_tr_b16 v[106:107], v28 offset:54272
    ds_read_b64_tr_b16 v[108:109], v29 offset:53248
    v_mfma_f32_32x32x16_bf16 v[176:191], v[140:143], v[128:131], v[176:191]
    ds_read_b64_tr_b16 v[110:111], v29 offset:54272
    s_waitcnt lgkmcnt(7)
    v_mfma_f32_32x32x16_bf16 v[144:159], v[84:87], v[80:83], v[144:159]
    ds_read_b128 v[112:115], v18 offset:0
    ds_read_b64_tr_b16 v[116:117], v24 offset:57344
    ds_read_b64_tr_b16 v[118:119], v24 offset:58368
    v_mfma_f32_32x32x16_bf16 v[160:175], v[88:91], v[80:83], v[160:175]
    ds_read_b64_tr_b16 v[120:121], v25 offset:57344
    ds_read_b64_tr_b16 v[122:123], v25 offset:58368
    ds_read_b64_tr_b16 v[124:125], v26 offset:57344
    v_mfma_f32_32x32x16_bf16 v[176:191], v[92:95], v[80:83], v[176:191]
    ds_read_b64_tr_b16 v[126:127], v26 offset:58368
    s_cbranch_vccnz P1C_nc19_0
    v_mfma_f32_16x16x32_bf16 v[60:63], v[44:47], v[84:87], v[60:63]
    v_mfma_f32_16x16x32_bf16 v[64:67], v[44:47], v[88:91], v[64:67]
    v_mfma_f32_16x16x32_bf16 v[68:71], v[44:47], v[92:95], v[68:71]
P1C_nc19_0:
    s_waitcnt lgkmcnt(7)
    v_mfma_f32_32x32x16_bf16 v[144:159], v[100:103], v[96:99], v[144:159]
    ds_read_b128 v[128:131], v19 offset:0
    ds_read_b64_tr_b16 v[132:133], v27 offset:61440
    ds_read_b64_tr_b16 v[134:135], v27 offset:62464
    v_mfma_f32_32x32x16_bf16 v[160:175], v[104:107], v[96:99], v[160:175]
    ds_read_b64_tr_b16 v[136:137], v28 offset:61440
    ds_read_b64_tr_b16 v[138:139], v28 offset:62464
    ds_read_b64_tr_b16 v[140:141], v29 offset:61440
    v_mfma_f32_32x32x16_bf16 v[176:191], v[108:111], v[96:99], v[176:191]
    ds_read_b64_tr_b16 v[142:143], v29 offset:62464
    s_waitcnt lgkmcnt(7)
    v_mfma_f32_32x32x16_bf16 v[144:159], v[116:119], v[112:115], v[144:159]
    v_mfma_f32_32x32x16_bf16 v[160:175], v[120:123], v[112:115], v[160:175]
    v_mfma_f32_32x32x16_bf16 v[176:191], v[124:127], v[112:115], v[176:191]
    s_cbranch_vccz P1C_nc19_2
    v_mfma_f32_16x16x32_bf16 v[60:63], v[44:47], v[116:119], v[60:63]
    v_mfma_f32_16x16x32_bf16 v[64:67], v[44:47], v[120:123], v[64:67]
    v_mfma_f32_16x16x32_bf16 v[68:71], v[44:47], v[124:127], v[68:71]
P1C_nc19_2:
    s_waitcnt lgkmcnt(0)
    v_mfma_f32_32x32x16_bf16 v[144:159], v[132:135], v[128:131], v[144:159]
    v_mfma_f32_32x32x16_bf16 v[160:175], v[136:139], v[128:131], v[160:175]
    v_mfma_f32_32x32x16_bf16 v[176:191], v[140:143], v[128:131], v[176:191]
    s_nop 3
    s_mov_b64 exec, 0xffff
    ds_write2st64_b32 v5, v60, v61 offset0:0 offset1:1
    ds_write2st64_b32 v5, v64, v65 offset0:2 offset1:3
    ds_write2st64_b32 v5, v68, v69 offset0:4 offset1:5
    s_mov_b64 exec, -1
    s_waitcnt lgkmcnt(0)
    s_barrier
    ds_read_b128 v[64:67], v6 offset:512
    ds_read_b128 v[68:71], v6 offset:1024
    ds_read_b128 v[60:63], v6 offset:0
    s_lshl_b32 s15, s12, 8
    s_add_u32 s15, s15, 147456
    v_lshl_add_u32 v11, v3, 3, s15
    v_mov_b32 v16, v7
    v_mov_b32 v56, 0
    v_mov_b32 v57, 0
    v_mov_b32 v53, 0x3f803f80
    s_waitcnt lgkmcnt(2)
    v_add_f32 v64, v64, v65
    v_add_f32 v66, v66, v67
    v_add_f32 v64, v64, v66
    v_cvt_pk_bf16_f32 v9, v64, v64
    v_and_b32 v9, 0xffff0000, v9
    v_sub_f32 v9, v64, v9
    v_cvt_pk_bf16_f32 v74, v64, v9
    v_and_b32 v10, 0xffff0000, v74
    v_sub_f32 v9, v9, v10
    v_cvt_pk_bf16_f32 v75, v9, 0
    s_nop 1
    v_mfma_f32_32x32x8_bf16 v[160:175], v[74:75], v[58:59], v[160:175]
    s_waitcnt lgkmcnt(1)
    v_add_f32 v68, v68, v69
    v_add_f32 v70, v70, v71
    v_add_f32 v68, v68, v70
    v_cvt_pk_bf16_f32 v9, v68, v68
    v_and_b32 v9, 0xffff0000, v9
    v_sub_f32 v9, v68, v9
    v_cvt_pk_bf16_f32 v76, v68, v9
    v_and_b32 v10, 0xffff0000, v76
    v_sub_f32 v9, v9, v10
    v_cvt_pk_bf16_f32 v77, v9, 0
    s_nop 1
    v_mfma_f32_32x32x8_bf16 v[176:191], v[76:77], v[58:59], v[176:191]
    s_waitcnt lgkmcnt(0)
    v_add_f32 v60, v60, v61
    v_add_f32 v62, v62, v63
    v_add_f32 v60, v60, v62
    v_cvt_pk_bf16_f32 v9, v60, v60
    v_and_b32 v9, 0xffff0000, v9
    v_sub_f32 v9, v60, v9
    v_cvt_pk_bf16_f32 v72, v60, v9
    v_and_b32 v10, 0xffff0000, v72
    v_sub_f32 v9, v9, v10
    v_cvt_pk_bf16_f32 v73, v9, 0
    s_nop 1
    v_mfma_f32_32x32x8_bf16 v[144:159], v[72:73], v[58:59], v[144:159]
    v_pk_mul_f32 v[96:97], v[168:169], v[168:169]
    v_pk_mul_f32 v[98:99], v[170:171], v[170:171]
    v_pk_mul_f32 v[100:101], v[172:173], v[172:173]
    v_pk_mul_f32 v[102:103], v[174:175], v[174:175]
    v_pk_fma_f32 v[96:97], v[96:97], v[50:51], v[48:49] op_sel_hi:[1,0,0]
    v_pk_fma_f32 v[98:99], v[98:99], v[50:51], v[48:49] op_sel_hi:[1,0,0]
    v_pk_fma_f32 v[100:101], v[100:101], v[50:51], v[48:49] op_sel_hi:[1,0,0]
    v_pk_fma_f32 v[102:103], v[102:103], v[50:51], v[48:49] op_sel_hi:[1,0,0]
    v_pk_mul_f32 v[96:97], v[96:97], v[168:169]
    v_pk_mul_f32 v[98:99], v[98:99], v[170:171]
    v_pk_mul_f32 v[100:101], v[100:101], v[172:173]
    v_pk_mul_f32 v[102:103], v[102:103], v[174:175]
    v_exp_f32 v96, v96
    v_exp_f32 v97, v97
    v_exp_f32 v98, v98
    v_exp_f32 v99, v99
    v_exp_f32 v100, v100
    v_exp_f32 v101, v101
    v_exp_f32 v102, v102
    v_exp_f32 v103, v103
    v_pk_fma_f32 v[96:97], v[96:97], v[54:55], v[54:55] op_sel_hi:[1,0,0]
    v_pk_fma_f32 v[98:99], v[98:99], v[54:55], v[54:55] op_sel_hi:[1,0,0]
    v_pk_fma_f32 v[100:101], v[100:101], v[54:55], v[54:55] op_sel_hi:[1,0,0]
    v_pk_fma_f32 v[102:103], v[102:103], v[54:55], v[54:55] op_sel_hi:[1,0,0]
    v_rcp_f32 v96, v96
    v_rcp_f32 v97, v97
    v_rcp_f32 v98, v98
    v_rcp_f32 v99, v99
    v_rcp_f32 v100, v100
    v_rcp_f32 v101, v101
    v_rcp_f32 v102, v102
    v_rcp_f32 v103, v103
    v_pk_mul_f32 v[168:169], v[168:169], v[96:97]
    v_pk_mul_f32 v[170:171], v[170:171], v[98:99]
    v_pk_mul_f32 v[172:173], v[172:173], v[100:101]
    v_pk_mul_f32 v[174:175], v[174:175], v[102:103]
    v_cvt_pk_bf16_f32 v112, v168, v169
    v_cvt_pk_bf16_f32 v113, v170, v171
    v_cvt_pk_bf16_f32 v114, v172, v173
    v_cvt_pk_bf16_f32 v115, v174, v175
    ds_write_b128 v16, v[112:115] offset:3072
    v_dot2c_f32_bf16 v56, v112, v53
    v_dot2c_f32_bf16 v57, v112, v112
    v_dot2c_f32_bf16 v56, v113, v53
    v_dot2c_f32_bf16 v57, v113, v113
    v_dot2c_f32_bf16 v56, v114, v53
    v_dot2c_f32_bf16 v57, v114, v114
    v_dot2c_f32_bf16 v56, v115, v53
    v_dot2c_f32_bf16 v57, v115, v115
    v_pk_mul_f32 v[104:105], v[176:177], v[176:177]
    v_pk_mul_f32 v[106:107], v[178:179], v[178:179]
    v_pk_mul_f32 v[108:109], v[180:181], v[180:181]
    v_pk_mul_f32 v[110:111], v[182:183], v[182:183]
    v_pk_fma_f32 v[104:105], v[104:105], v[50:51], v[48:49] op_sel_hi:[1,0,0]
    v_pk_fma_f32 v[106:107], v[106:107], v[50:51], v[48:49] op_sel_hi:[1,0,0]
    v_pk_fma_f32 v[108:109], v[108:109], v[50:51], v[48:49] op_sel_hi:[1,0,0]
    v_pk_fma_f32 v[110:111], v[110:111], v[50:51], v[48:49] op_sel_hi:[1,0,0]
    v_pk_mul_f32 v[104:105], v[104:105], v[176:177]
    v_pk_mul_f32 v[106:107], v[106:107], v[178:179]
    v_pk_mul_f32 v[108:109], v[108:109], v[180:181]
    v_pk_mul_f32 v[110:111], v[110:111], v[182:183]
    v_exp_f32 v104, v104
    v_exp_f32 v105, v105
    v_exp_f32 v106, v106
    v_exp_f32 v107, v107
    v_exp_f32 v108, v108
    v_exp_f32 v109, v109
    v_exp_f32 v110, v110
    v_exp_f32 v111, v111
    v_pk_fma_f32 v[104:105], v[104:105], v[54:55], v[54:55] op_sel_hi:[1,0,0]
    v_pk_fma_f32 v[106:107], v[106:107], v[54:55], v[54:55] op_sel_hi:[1,0,0]
    v_pk_fma_f32 v[108:109], v[108:109], v[54:55], v[54:55] op_sel_hi:[1,0,0]
    v_pk_fma_f32 v[110:111], v[110:111], v[54:55], v[54:55] op_sel_hi:[1,0,0]
    v_rcp_f32 v104, v104
    v_rcp_f32 v105, v105
    v_rcp_f32 v106, v106
    v_rcp_f32 v107, v107
    v_rcp_f32 v108, v108
    v_rcp_f32 v109, v109
    v_rcp_f32 v110, v110
    v_rcp_f32 v111, v111
    v_pk_mul_f32 v[176:177], v[176:177], v[104:105]
    v_pk_mul_f32 v[178:179], v[178:179], v[106:107]
    v_pk_mul_f32 v[180:181], v[180:181], v[108:109]
    v_pk_mul_f32 v[182:183], v[182:183], v[110:111]
    v_cvt_pk_bf16_f32 v116, v176, v177
    v_cvt_pk_bf16_f32 v117, v178, v179
    v_cvt_pk_bf16_f32 v118, v180, v181
    v_cvt_pk_bf16_f32 v119, v182, v183
    ds_write_b128 v16, v[116:119] offset:4096
    v_dot2c_f32_bf16 v56, v116, v53
    v_dot2c_f32_bf16 v57, v116, v116
    v_dot2c_f32_bf16 v56, v117, v53
    v_dot2c_f32_bf16 v57, v117, v117
    v_dot2c_f32_bf16 v56, v118, v53
    v_dot2c_f32_bf16 v57, v118, v118
    v_dot2c_f32_bf16 v56, v119, v53
    v_dot2c_f32_bf16 v57, v119, v119
    v_pk_mul_f32 v[96:97], v[184:185], v[184:185]
    v_pk_mul_f32 v[98:99], v[186:187], v[186:187]
    v_pk_mul_f32 v[100:101], v[188:189], v[188:189]
    v_pk_mul_f32 v[102:103], v[190:191], v[190:191]
    v_pk_fma_f32 v[96:97], v[96:97], v[50:51], v[48:49] op_sel_hi:[1,0,0]
    v_pk_fma_f32 v[98:99], v[98:99], v[50:51], v[48:49] op_sel_hi:[1,0,0]
    v_pk_fma_f32 v[100:101], v[100:101], v[50:51], v[48:49] op_sel_hi:[1,0,0]
    v_pk_fma_f32 v[102:103], v[102:103], v[50:51], v[48:49] op_sel_hi:[1,0,0]
    v_pk_mul_f32 v[96:97], v[96:97], v[184:185]
    v_pk_mul_f32 v[98:99], v[98:99], v[186:187]
    v_pk_mul_f32 v[100:101], v[100:101], v[188:189]
    v_pk_mul_f32 v[102:103], v[102:103], v[190:191]
    v_exp_f32 v96, v96
    v_exp_f32 v97, v97
    v_exp_f32 v98, v98
    v_exp_f32 v99, v99
    v_exp_f32 v100, v100
    v_exp_f32 v101, v101
    v_exp_f32 v102, v102
    v_exp_f32 v103, v103
    v_pk_fma_f32 v[96:97], v[96:97], v[54:55], v[54:55] op_sel_hi:[1,0,0]
    v_pk_fma_f32 v[98:99], v[98:99], v[54:55], v[54:55] op_sel_hi:[1,0,0]
    v_pk_fma_f32 v[100:101], v[100:101], v[54:55], v[54:55] op_sel_hi:[1,0,0]
    v_pk_fma_f32 v[102:103], v[102:103], v[54:55], v[54:55] op_sel_hi:[1,0,0]
    v_rcp_f32 v96, v96
    v_rcp_f32 v97, v97
    v_rcp_f32 v98, v98
    v_rcp_f32 v99, v99
    v_rcp_f32 v100, v100
    v_rcp_f32 v101, v101
    v_rcp_f32 v102, v102
    v_rcp_f32 v103, v103
    v_pk_mul_f32 v[184:185], v[184:185], v[96:97]
    v_pk_mul_f32 v[186:187], v[186:187], v[98:99]
    v_pk_mul_f32 v[188:189], v[188:189], v[100:101]
    v_pk_mul_f32 v[190:191], v[190:191], v[102:103]
    v_cvt_pk_bf16_f32 v120, v184, v185
    v_cvt_pk_bf16_f32 v121, v186, v187
    v_cvt_pk_bf16_f32 v122, v188, v189
    v_cvt_pk_bf16_f32 v123, v190, v191
    ds_write_b128 v16, v[120:123] offset:5120
    v_dot2c_f32_bf16 v56, v120, v53
    v_dot2c_f32_bf16 v57, v120, v120
    v_dot2c_f32_bf16 v56, v121, v53
    v_dot2c_f32_bf16 v57, v121, v121
    v_dot2c_f32_bf16 v56, v122, v53
    v_dot2c_f32_bf16 v57, v122, v122
    v_dot2c_f32_bf16 v56, v123, v53
    v_dot2c_f32_bf16 v57, v123, v123
    s_nop 2
    v_mov_b32 v58, v56
    v_mov_b32 v59, v57
    s_nop 1
    v_permlane32_swap_b32 v56, v58
    v_permlane32_swap_b32 v57, v59
    v_add_f32 v56, v56, v58
    v_add_f32 v57, v57, v59
    ds_write_b64 v11, v[56:57]
    s_waitcnt lgkmcnt(0)
    s_barrier
    s_and_b32 s35, s12, 1
    s_lshr_b32 s36, s12, 1
    s_lshl_b32 s37, s14, 2
    s_lshl_b32 s15, s35, 1
    s_add_u32 s37, s37, s15
    s_add_u32 s38, s37, s36
    s_xor_b32 s39, s38, 1
    v_lshlrev_b32 v5, 2, v4
    v_xor_b32 v5, v5, v3
    v_lshlrev_b32 v5, 4, v5
    v_lshl_add_u32 v6, v4, 15, v5
    v_xor_b32 v7, 8, v3
    v_lshlrev_b32 v7, 4, v7
    s_lshl_b32 s15, s32, 3
    v_add_u32 v7, s15, v7
    s_lshl_b32 s40, s34, 5
    s_add_u32 s41, s40, s39
    s_add_u32 s40, s40, s38
    s_lshl_b32 s40, s40, 10
    s_lshl_b32 s41, s41, 10
    s_lshl_b32 s42, s33, 5
    s_add_u32 s43, s42, s39
    s_add_u32 s42, s42, s38
    s_lshl_b32 s42, s42, 10
    s_lshl_b32 s43, s43, 10
    v_mov_b32 v36, 0
    v_mov_b32 v37, 0
    v_mov_b32 v38, 0
    v_mov_b32 v39, 0
    v_mov_b32 v40, 0
    v_mov_b32 v41, 0
    v_mov_b32 v42, 0
    v_mov_b32 v43, 0
    buffer_load_dwordx4 v[20:23], v6, s[24:27], s40 offen offset:0 sc1
    buffer_load_dwordx4 v[24:27], v6, s[24:27], s40 offen offset:512 sc1
    buffer_load_dwordx4 v[28:31], v6, s[24:27], s41 offen offset:0 sc1
    buffer_load_dwordx4 v[32:35], v6, s[24:27], s41 offen offset:512 sc1
    s_mov_b32 exec_hi, 0
    buffer_load_dwordx2 v[36:37], v7, s[24:27], s42 offen offset:0 sc1
    buffer_load_dwordx2 v[38:39], v7, s[24:27], s42 offen offset:512 sc1
    buffer_load_dwordx2 v[40:41], v7, s[24:27], s43 offen offset:0 sc1
    buffer_load_dwordx2 v[42:43], v7, s[24:27], s43 offen offset:512 sc1
    s_mov_b32 exec_hi, -1
    v_pk_mul_f32 v[104:105], v[144:145], v[144:145]
    v_pk_mul_f32 v[106:107], v[146:147], v[146:147]
    v_pk_mul_f32 v[108:109], v[148:149], v[148:149]
    v_pk_mul_f32 v[110:111], v[150:151], v[150:151]
    v_pk_fma_f32 v[104:105], v[104:105], v[50:51], v[48:49] op_sel_hi:[1,0,0]
    v_pk_fma_f32 v[106:107], v[106:107], v[50:51], v[48:49] op_sel_hi:[1,0,0]
    v_pk_fma_f32 v[108:109], v[108:109], v[50:51], v[48:49] op_sel_hi:[1,0,0]
    v_pk_fma_f32 v[110:111], v[110:111], v[50:51], v[48:49] op_sel_hi:[1,0,0]
    v_pk_mul_f32 v[104:105], v[104:105], v[144:145]
    v_pk_mul_f32 v[106:107], v[106:107], v[146:147]
    v_pk_mul_f32 v[108:109], v[108:109], v[148:149]
    v_pk_mul_f32 v[110:111], v[110:111], v[150:151]
    v_exp_f32 v104, v104
    v_exp_f32 v105, v105
    v_exp_f32 v106, v106
    v_exp_f32 v107, v107
    v_exp_f32 v108, v108
    v_exp_f32 v109, v109
    v_exp_f32 v110, v110
    v_exp_f32 v111, v111
    v_pk_fma_f32 v[104:105], v[104:105], v[54:55], v[54:55] op_sel_hi:[1,0,0]
    v_pk_fma_f32 v[106:107], v[106:107], v[54:55], v[54:55] op_sel_hi:[1,0,0]
    v_pk_fma_f32 v[108:109], v[108:109], v[54:55], v[54:55] op_sel_hi:[1,0,0]
    v_pk_fma_f32 v[110:111], v[110:111], v[54:55], v[54:55] op_sel_hi:[1,0,0]
    v_rcp_f32 v104, v104
    v_rcp_f32 v105, v105
    v_rcp_f32 v106, v106
    v_rcp_f32 v107, v107
    v_rcp_f32 v108, v108
    v_rcp_f32 v109, v109
    v_rcp_f32 v110, v110
    v_rcp_f32 v111, v111
    v_pk_mul_f32 v[144:145], v[144:145], v[104:105]
    v_pk_mul_f32 v[146:147], v[146:147], v[106:107]
    v_pk_mul_f32 v[148:149], v[148:149], v[108:109]
    v_pk_mul_f32 v[150:151], v[150:151], v[110:111]
    v_cvt_pk_bf16_f32 v124, v144, v145
    v_cvt_pk_bf16_f32 v125, v146, v147
    v_cvt_pk_bf16_f32 v126, v148, v149
    v_cvt_pk_bf16_f32 v127, v150, v151
    ds_write_b128 v16, v[124:127] offset:0
    v_pk_mul_f32 v[96:97], v[152:153], v[152:153]
    v_pk_mul_f32 v[98:99], v[154:155], v[154:155]
    v_pk_mul_f32 v[100:101], v[156:157], v[156:157]
    v_pk_mul_f32 v[102:103], v[158:159], v[158:159]
    v_pk_fma_f32 v[96:97], v[96:97], v[50:51], v[48:49] op_sel_hi:[1,0,0]
    v_pk_fma_f32 v[98:99], v[98:99], v[50:51], v[48:49] op_sel_hi:[1,0,0]
    v_pk_fma_f32 v[100:101], v[100:101], v[50:51], v[48:49] op_sel_hi:[1,0,0]
    v_pk_fma_f32 v[102:103], v[102:103], v[50:51], v[48:49] op_sel_hi:[1,0,0]
    v_pk_mul_f32 v[96:97], v[96:97], v[152:153]
    v_pk_mul_f32 v[98:99], v[98:99], v[154:155]
    v_pk_mul_f32 v[100:101], v[100:101], v[156:157]
    v_pk_mul_f32 v[102:103], v[102:103], v[158:159]
    v_exp_f32 v96, v96
    v_exp_f32 v97, v97
    v_exp_f32 v98, v98
    v_exp_f32 v99, v99
    v_exp_f32 v100, v100
    v_exp_f32 v101, v101
    v_exp_f32 v102, v102
    v_exp_f32 v103, v103
    v_pk_fma_f32 v[96:97], v[96:97], v[54:55], v[54:55] op_sel_hi:[1,0,0]
    v_pk_fma_f32 v[98:99], v[98:99], v[54:55], v[54:55] op_sel_hi:[1,0,0]
    v_pk_fma_f32 v[100:101], v[100:101], v[54:55], v[54:55] op_sel_hi:[1,0,0]
    v_pk_fma_f32 v[102:103], v[102:103], v[54:55], v[54:55] op_sel_hi:[1,0,0]
    v_rcp_f32 v96, v96
    v_rcp_f32 v97, v97
    v_rcp_f32 v98, v98
    v_rcp_f32 v99, v99
    v_rcp_f32 v100, v100
    v_rcp_f32 v101, v101
    v_rcp_f32 v102, v102
    v_rcp_f32 v103, v103
    v_pk_mul_f32 v[152:153], v[152:153], v[96:97]
    v_pk_mul_f32 v[154:155], v[154:155], v[98:99]
    v_pk_mul_f32 v[156:157], v[156:157], v[100:101]
    v_pk_mul_f32 v[158:159], v[158:159], v[102:103]
    v_cvt_pk_bf16_f32 v112, v152, v153
    v_cvt_pk_bf16_f32 v113, v154, v155
    v_cvt_pk_bf16_f32 v114, v156, v157
    v_cvt_pk_bf16_f32 v115, v158, v159
    ds_write_b128 v16, v[112:115] offset:1024
    v_pk_mul_f32 v[104:105], v[160:161], v[160:161]
    v_pk_mul_f32 v[106:107], v[162:163], v[162:163]
    v_pk_mul_f32 v[108:109], v[164:165], v[164:165]
    v_pk_mul_f32 v[110:111], v[166:167], v[166:167]
    v_pk_fma_f32 v[104:105], v[104:105], v[50:51], v[48:49] op_sel_hi:[1,0,0]
    v_pk_fma_f32 v[106:107], v[106:107], v[50:51], v[48:49] op_sel_hi:[1,0,0]
    v_pk_fma_f32 v[108:109], v[108:109], v[50:51], v[48:49] op_sel_hi:[1,0,0]
    v_pk_fma_f32 v[110:111], v[110:111], v[50:51], v[48:49] op_sel_hi:[1,0,0]
    v_pk_mul_f32 v[104:105], v[104:105], v[160:161]
    v_pk_mul_f32 v[106:107], v[106:107], v[162:163]
    v_pk_mul_f32 v[108:109], v[108:109], v[164:165]
    v_pk_mul_f32 v[110:111], v[110:111], v[166:167]
    v_exp_f32 v104, v104
    v_exp_f32 v105, v105
    v_exp_f32 v106, v106
    v_exp_f32 v107, v107
    v_exp_f32 v108, v108
    v_exp_f32 v109, v109
    v_exp_f32 v110, v110
    v_exp_f32 v111, v111
    v_pk_fma_f32 v[104:105], v[104:105], v[54:55], v[54:55] op_sel_hi:[1,0,0]
    v_pk_fma_f32 v[106:107], v[106:107], v[54:55], v[54:55] op_sel_hi:[1,0,0]
    v_pk_fma_f32 v[108:109], v[108:109], v[54:55], v[54:55] op_sel_hi:[1,0,0]
    v_pk_fma_f32 v[110:111], v[110:111], v[54:55], v[54:55] op_sel_hi:[1,0,0]
    v_rcp_f32 v104, v104
    v_rcp_f32 v105, v105
    v_rcp_f32 v106, v106
    v_rcp_f32 v107, v107
    v_rcp_f32 v108, v108
    v_rcp_f32 v109, v109
    v_rcp_f32 v110, v110
    v_rcp_f32 v111, v111
    v_pk_mul_f32 v[160:161], v[160:161], v[104:105]
    v_pk_mul_f32 v[162:163], v[162:163], v[106:107]
    v_pk_mul_f32 v[164:165], v[164:165], v[108:109]
    v_pk_mul_f32 v[166:167], v[166:167], v[110:111]
    v_cvt_pk_bf16_f32 v116, v160, v161
    v_cvt_pk_bf16_f32 v117, v162, v163
    v_cvt_pk_bf16_f32 v118, v164, v165
    v_cvt_pk_bf16_f32 v119, v166, v167
    ds_write_b128 v16, v[116:119] offset:2048
    v_mov_b32 v112, 0
    v_mov_b32 v64, 0
    v_mov_b32 v113, 0
    v_mov_b32 v65, 0
    v_mov_b32 v114, 0
    v_mov_b32 v66, 0
    v_mov_b32 v115, 0
    v_mov_b32 v67, 0
    v_mov_b32 v116, 0
    v_mov_b32 v68, 0
    v_mov_b32 v117, 0
    v_mov_b32 v69, 0
    v_mov_b32 v118, 0
    v_mov_b32 v70, 0
    v_mov_b32 v119, 0
    v_mov_b32 v71, 0
    s_mov_b32 s54, 0
    s_mov_b32 s48, 0
    s_mov_b32 s49, 0
    s_mov_b32 s52, 0x5d800000
    s_waitcnt vmcnt(0) lgkmcnt(0)
    s_barrier
    ds_read_b128 v[44:47], v12 offset:0
    ds_read_b64 v[52:53], v13 offset:0
    ds_read_b128 v[48:51], v12 offset:512
    ds_read_b64 v[54:55], v13 offset:512
    ds_read_b64_tr_b16 v[56:57], v14 offset:0
    ds_read_b64_tr_b16 v[58:59], v15 offset:0
    ds_read_b64_tr_b16 v[60:61], v14 offset:256
    ds_read_b64_tr_b16 v[62:63], v15 offset:256
    s_waitcnt lgkmcnt(6)
    v_mfma_f32_32x32x16_bf16 v[72:87], v[44:47], v[20:23], 0
    s_mul_i32 s15, s12, 6656
    s_add_u32 s15, s15, 125952
    v_lshl_add_u32 v152, v2, 4, s15
    v_lshl_add_u32 v153, v2, 2, s15
    s_xor_b32 s15, s12, 2
    v_mfma_f32_32x32x8_bf16 v[72:87], v[52:53], v[36:37], v[72:87]
    s_mul_i32 s15, s15, 6656
    s_add_u32 s15, s15, 125952
    v_lshl_add_u32 v154, v2, 4, s15
    v_lshl_add_u32 v155, v2, 2, s15
    v_lshrrev_b32 v156, 4, v3
    v_mfma_f32_32x32x16_bf16 v[88:103], v[44:47], v[24:27], 0
    v_mul_u32_u24 v156, 45056, v156
    v_and_b32 v157, 15, v3
    v_lshl_add_u32 v156, v157, 4, v156
    v_lshl_add_u32 v156, v4, 8, v156
    s_lshl_b32 s15, s12, 2
    v_mfma_f32_32x32x8_bf16 v[88:103], v[52:53], v[38:39], v[88:103]
    s_add_u32 s15, s15, 162816
    v_mov_b32 v157, s15
    v_xor_b32 v158, 8, v157
    v_lshlrev_b32 v159, 4, v2
    v_mfma_f32_32x32x16_bf16 v[120:135], v[44:47], v[28:31], 0
    v_max3_f32 v72, v72, v73, v74
    v_max3_f32 v72, v72, v75, v76
    v_max3_f32 v72, v72, v77, v78
    v_max3_f32 v72, v72, v79, v80
    v_max3_f32 v72, v72, v81, v82
    v_mfma_f32_32x32x8_bf16 v[120:135], v[52:53], v[40:41], v[120:135]
    v_max3_f32 v72, v72, v83, v84
    v_max3_f32 v72, v72, v85, v86
    v_max_f32 v72, v72, v87
    v_mov_b32 v73, v72
    v_mfma_f32_32x32x16_bf16 v[136:151], v[44:47], v[32:35], 0
    v_max3_f32 v88, v88, v89, v90
    v_max3_f32 v88, v88, v91, v92
    v_max3_f32 v88, v88, v93, v94
    v_max3_f32 v88, v88, v95, v96
    v_max3_f32 v88, v88, v97, v98
    v_mfma_f32_32x32x8_bf16 v[136:151], v[52:53], v[42:43], v[136:151]
    v_max3_f32 v88, v88, v99, v100
    v_max3_f32 v88, v88, v101, v102
    v_max_f32 v88, v88, v103
    v_mov_b32 v89, v88
    v_max3_f32 v120, v120, v121, v122
    v_max3_f32 v120, v120, v123, v124
    v_max3_f32 v120, v120, v125, v126
    v_max3_f32 v120, v120, v127, v128
    v_max3_f32 v120, v120, v129, v130
    v_max3_f32 v120, v120, v131, v132
    v_max3_f32 v120, v120, v133, v134
    v_max_f32 v120, v120, v135
    v_mov_b32 v121, v120
    v_max3_f32 v136, v136, v137, v138
    v_max3_f32 v136, v136, v139, v140
    v_max3_f32 v136, v136, v141, v142
    v_max3_f32 v136, v136, v143, v144
    v_max3_f32 v136, v136, v145, v146
    v_max3_f32 v136, v136, v147, v148
    v_max3_f32 v136, v136, v149, v150
    v_max_f32 v136, v136, v151
    v_mov_b32 v137, v136
    s_nop 0
    v_permlane32_swap_b32 v72, v73
    v_permlane32_swap_b32 v88, v89
    v_permlane32_swap_b32 v120, v121
    v_permlane32_swap_b32 v136, v137
    v_max_f32 v72, v72, v73
    v_add_f32 v72, 0x42a00000, v72
    v_rndne_f32 v72, v72
    v_cvt_pk_bf16_f32 v16, v72, v72
    v_and_b32 v16, 0xffff0000, v16
    v_sub_f32 v72, v72, v16
    v_cvt_pk_bf16_f32 v5, -v16, -v72
    v_max_f32 v88, v88, v89
    v_add_f32 v88, 0x42a00000, v88
    v_rndne_f32 v88, v88
    v_cvt_pk_bf16_f32 v17, v88, v88
    v_and_b32 v17, 0xffff0000, v17
    v_sub_f32 v88, v88, v17
    v_cvt_pk_bf16_f32 v6, -v17, -v88
    v_max_f32 v120, v120, v121
    v_add_f32 v120, 0x42a00000, v120
    v_rndne_f32 v120, v120
    v_cvt_pk_bf16_f32 v18, v120, v120
    v_and_b32 v18, 0xffff0000, v18
    v_sub_f32 v120, v120, v18
    v_cvt_pk_bf16_f32 v7, -v18, -v120
    v_max_f32 v136, v136, v137
    v_add_f32 v136, 0x42a00000, v136
    v_rndne_f32 v136, v136
    v_cvt_pk_bf16_f32 v19, v136, v136
    v_and_b32 v19, 0xffff0000, v19
    v_sub_f32 v136, v136, v19
    v_cvt_pk_bf16_f32 v8, -v19, -v136
    s_mov_b32 exec_lo, 0
    v_mov_b32 v36, v5
    v_mov_b32 v38, v6
    v_mov_b32 v40, v7
    v_mov_b32 v42, v8
    s_mov_b32 exec_lo, -1
    v_mfma_f32_32x32x16_bf16 v[72:87], v[44:47], v[20:23], 0
    v_mfma_f32_32x32x8_bf16 v[72:87], v[52:53], v[36:37], v[72:87]
    v_and_b32 v5, 0xffff0000, v5
    v_sub_f32 v16, v16, v5
    v_and_b32 v6, 0xffff0000, v6
    v_sub_f32 v17, v17, v6
    v_and_b32 v7, 0xffff0000, v7
    v_sub_f32 v18, v18, v7
    v_and_b32 v8, 0xffff0000, v8
    v_sub_f32 v19, v19, v8
    s_nop 2
    s_waitcnt lgkmcnt(0)
K2A_loop:
    v_mfma_f32_32x32x16_bf16 v[240:255], v[64:67], v[112:115], v[240:255]
    v_exp_f32 v72, v72
    v_exp_f32 v73, v73
    v_exp_f32 v74, v74
    v_exp_f32 v75, v75
    v_mfma_f32_32x32x16_bf16 v[88:103], v[44:47], v[24:27], 0
    v_exp_f32 v76, v76
    v_exp_f32 v77, v77
    v_exp_f32 v78, v78
    v_exp_f32 v79, v79
    v_cvt_pk_bf16_f32 v104, v72, v73
    v_cvt_pk_bf16_f32 v105, v74, v75
    v_mfma_f32_32x32x8_bf16 v[88:103], v[52:53], v[38:39], v[88:103]
    v_exp_f32 v80, v80
    v_exp_f32 v81, v81
    v_exp_f32 v82, v82
    v_exp_f32 v83, v83
    v_cvt_pk_bf16_f32 v106, v76, v77
    v_cvt_pk_bf16_f32 v107, v78, v79
    v_mfma_f32_32x32x16_bf16 v[240:255], v[68:71], v[116:119], v[240:255]
    v_exp_f32 v84, v84
    v_exp_f32 v85, v85
    v_exp_f32 v86, v86
    v_exp_f32 v87, v87
    v_cvt_pk_bf16_f32 v108, v80, v81
    v_cvt_pk_bf16_f32 v109, v82, v83
    v_cvt_pk_bf16_f32 v110, v84, v85
    v_cvt_pk_bf16_f32 v111, v86, v87
    v_mfma_f32_32x32x16_bf16 v[192:207], v[56:59], v[104:107], v[192:207]
    ds_read_b64_tr_b16 v[64:65], v14 offset:512
    v_exp_f32 v88, v88
    v_exp_f32 v89, v89
    v_exp_f32 v90, v90
    v_exp_f32 v91, v91
    v_mfma_f32_32x32x16_bf16 v[72:87], v[44:47], v[28:31], 0
    ds_read_b64_tr_b16 v[66:67], v15 offset:512
    v_exp_f32 v92, v92
    v_exp_f32 v93, v93
    v_exp_f32 v94, v94
    v_exp_f32 v95, v95
    v_cvt_pk_bf16_f32 v112, v88, v89
    v_cvt_pk_bf16_f32 v113, v90, v91
    v_mfma_f32_32x32x8_bf16 v[72:87], v[52:53], v[40:41], v[72:87]
    v_exp_f32 v96, v96
    v_exp_f32 v97, v97
    v_exp_f32 v98, v98
    v_exp_f32 v99, v99
    v_cvt_pk_bf16_f32 v114, v92, v93
    v_cvt_pk_bf16_f32 v115, v94, v95
    v_mfma_f32_32x32x16_bf16 v[192:207], v[60:63], v[108:111], v[192:207]
    v_exp_f32 v100, v100
    v_exp_f32 v101, v101
    v_exp_f32 v102, v102
    v_exp_f32 v103, v103
    v_cvt_pk_bf16_f32 v116, v96, v97
    v_cvt_pk_bf16_f32 v117, v98, v99
    v_cvt_pk_bf16_f32 v118, v100, v101
    v_cvt_pk_bf16_f32 v119, v102, v103
    v_mfma_f32_32x32x16_bf16 v[208:223], v[56:59], v[112:115], v[208:223]
    ds_read_b64_tr_b16 v[68:69], v14 offset:768
    v_exp_f32 v72, v72
    v_exp_f32 v73, v73
    v_exp_f32 v74, v74
    v_exp_f32 v75, v75
    v_mfma_f32_32x32x16_bf16 v[88:103], v[44:47], v[32:35], 0
    ds_read_b64_tr_b16 v[70:71], v15 offset:768
    v_exp_f32 v76, v76
    v_exp_f32 v77, v77
    v_exp_f32 v78, v78
    v_exp_f32 v79, v79
    v_cvt_pk_bf16_f32 v104, v72, v73
    v_cvt_pk_bf16_f32 v105, v74, v75
    v_mfma_f32_32x32x8_bf16 v[88:103], v[52:53], v[42:43], v[88:103]
    v_exp_f32 v80, v80
    v_exp_f32 v81, v81
    v_exp_f32 v82, v82
    v_exp_f32 v83, v83
    v_cvt_pk_bf16_f32 v106, v76, v77
    v_cvt_pk_bf16_f32 v107, v78, v79
    v_mfma_f32_32x32x16_bf16 v[208:223], v[60:63], v[116:119], v[208:223]
    v_exp_f32 v84, v84
    v_exp_f32 v85, v85
    v_exp_f32 v86, v86
    v_exp_f32 v87, v87
    v_cvt_pk_bf16_f32 v108, v80, v81
    v_cvt_pk_bf16_f32 v109, v82, v83
    v_cvt_pk_bf16_f32 v110, v84, v85
    v_cvt_pk_bf16_f32 v111, v86, v87
    v_mfma_f32_32x32x16_bf16 v[224:239], v[56:59], v[104:107], v[224:239]
    s_waitcnt lgkmcnt(0)
    v_exp_f32 v88, v88
    v_exp_f32 v89, v89
    v_exp_f32 v90, v90
    v_exp_f32 v91, v91
    v_mfma_f32_32x32x16_bf16 v[72:87], v[48:51], v[20:23], 0
    s_add_u32 s49, s49, 1
    v_exp_f32 v92, v92
    v_exp_f32 v93, v93
    v_exp_f32 v94, v94
    v_exp_f32 v95, v95
    v_cvt_pk_bf16_f32 v112, v88, v89
    v_cvt_pk_bf16_f32 v113, v90, v91
    v_mfma_f32_32x32x8_bf16 v[72:87], v[54:55], v[36:37], v[72:87]
    s_cmp_eq_u32 s49, 3
    v_exp_f32 v96, v96
    v_exp_f32 v97, v97
    v_exp_f32 v98, v98
    v_exp_f32 v99, v99
    v_cvt_pk_bf16_f32 v114, v92, v93
    v_cvt_pk_bf16_f32 v115, v94, v95
    v_mfma_f32_32x32x16_bf16 v[224:239], v[60:63], v[108:111], v[224:239]
    s_movk_i32 s53, 13312
    s_cmovk_i32 s53, 38912
    s_cmov_b32 s49, 0
    v_exp_f32 v100, v100
    v_exp_f32 v101, v101
    v_exp_f32 v102, v102
    v_exp_f32 v103, v103
    v_cvt_pk_bf16_f32 v116, v96, v97
    v_cvt_pk_bf16_f32 v117, v98, v99
    v_cvt_pk_bf16_f32 v118, v100, v101
    v_cvt_pk_bf16_f32 v119, v102, v103
    v_mfma_f32_32x32x16_bf16 v[240:255], v[56:59], v[112:115], v[240:255]
    s_cmp_eq_u32 s48, 7
    s_cbranch_scc1 K2A_nb4
    s_barrier
K2A_nb4:
    v_exp_f32 v72, v72
    v_exp_f32 v73, v73
    v_exp_f32 v74, v74
    v_exp_f32 v75, v75
    v_add_u32 v12, s53, v12
    v_add_u32 v13, s53, v13
    v_add_u32 v14, s53, v14
    v_add_u32 v15, s53, v15
    v_mfma_f32_32x32x16_bf16 v[88:103], v[48:51], v[24:27], 0
    ds_read_b128 v[44:47], v12 offset:0
    v_exp_f32 v76, v76
    v_exp_f32 v77, v77
    v_exp_f32 v78, v78
    v_exp_f32 v79, v79
    v_cvt_pk_bf16_f32 v104, v72, v73
    v_cvt_pk_bf16_f32 v105, v74, v75
    v_mfma_f32_32x32x8_bf16 v[88:103], v[54:55], v[38:39], v[88:103]
    ds_read_b64 v[52:53], v13 offset:0
    v_exp_f32 v80, v80
    v_exp_f32 v81, v81
    v_exp_f32 v82, v82
    v_exp_f32 v83, v83
    v_cvt_pk_bf16_f32 v106, v76, v77
    v_cvt_pk_bf16_f32 v107, v78, v79
    v_mfma_f32_32x32x16_bf16 v[240:255], v[60:63], v[116:119], v[240:255]
    v_exp_f32 v84, v84
    v_exp_f32 v85, v85
    v_exp_f32 v86, v86
    v_exp_f32 v87, v87
    v_cvt_pk_bf16_f32 v108, v80, v81
    v_cvt_pk_bf16_f32 v109, v82, v83
    v_cvt_pk_bf16_f32 v110, v84, v85
    v_cvt_pk_bf16_f32 v111, v86, v87
    v_mfma_f32_32x32x16_bf16 v[192:207], v[64:67], v[104:107], v[192:207]
    ds_read_b64_tr_b16 v[56:57], v14 offset:0
    v_exp_f32 v88, v88
    v_exp_f32 v89, v89
    v_exp_f32 v90, v90
    v_exp_f32 v91, v91
    v_mfma_f32_32x32x16_bf16 v[72:87], v[48:51], v[28:31], 0
    ds_read_b64_tr_b16 v[58:59], v15 offset:0
    v_exp_f32 v92, v92
    v_exp_f32 v93, v93
    v_exp_f32 v94, v94
    v_exp_f32 v95, v95
    v_cvt_pk_bf16_f32 v112, v88, v89
    v_cvt_pk_bf16_f32 v113, v90, v91
    v_mfma_f32_32x32x8_bf16 v[72:87], v[54:55], v[40:41], v[72:87]
    v_exp_f32 v96, v96
    v_exp_f32 v97, v97
    v_exp_f32 v98, v98
    v_exp_f32 v99, v99
    v_cvt_pk_bf16_f32 v114, v92, v93
    v_cvt_pk_bf16_f32 v115, v94, v95
    v_mfma_f32_32x32x16_bf16 v[192:207], v[68:71], v[108:111], v[192:207]
    v_exp_f32 v100, v100
    v_exp_f32 v101, v101
    v_exp_f32 v102, v102
    v_exp_f32 v103, v103
    v_cvt_pk_bf16_f32 v116, v96, v97
    v_cvt_pk_bf16_f32 v117, v98, v99
    v_cvt_pk_bf16_f32 v118, v100, v101
    v_cvt_pk_bf16_f32 v119, v102, v103
    v_mfma_f32_32x32x16_bf16 v[208:223], v[64:67], v[112:115], v[208:223]
    ds_read_b64_tr_b16 v[60:61], v14 offset:256
    v_exp_f32 v72, v72
    v_exp_f32 v73, v73
    v_exp_f32 v74, v74
    v_exp_f32 v75, v75
    v_mfma_f32_32x32x16_bf16 v[88:103], v[48:51], v[32:35], 0
    ds_read_b64_tr_b16 v[62:63], v15 offset:256
    v_exp_f32 v76, v76
    v_exp_f32 v77, v77
    v_exp_f32 v78, v78
    v_exp_f32 v79, v79
    v_cvt_pk_bf16_f32 v104, v72, v73
    v_cvt_pk_bf16_f32 v105, v74, v75
    v_mfma_f32_32x32x8_bf16 v[88:103], v[54:55], v[42:43], v[88:103]
    v_exp_f32 v80, v80
    v_exp_f32 v81, v81
    v_exp_f32 v82, v82
    v_exp_f32 v83, v83
    v_cvt_pk_bf16_f32 v106, v76, v77
    v_cvt_pk_bf16_f32 v107, v78, v79
    v_mfma_f32_32x32x16_bf16 v[208:223], v[68:71], v[116:119], v[208:223]
    v_exp_f32 v84, v84
    v_exp_f32 v85, v85
    v_exp_f32 v86, v86
    v_exp_f32 v87, v87
    v_cvt_pk_bf16_f32 v108, v80, v81
    v_cvt_pk_bf16_f32 v109, v82, v83
    v_cvt_pk_bf16_f32 v110, v84, v85
    v_cvt_pk_bf16_f32 v111, v86, v87
    v_mfma_f32_32x32x16_bf16 v[224:239], v[64:67], v[104:107], v[224:239]
    s_waitcnt lgkmcnt(0)
    v_exp_f32 v88, v88
    v_exp_f32 v89, v89
    v_exp_f32 v90, v90
    v_exp_f32 v91, v91
    v_mfma_f32_32x32x16_bf16 v[72:87], v[44:47], v[20:23], 0
    ds_read_b128 v[48:51], v12 offset:512
    v_exp_f32 v92, v92
    v_exp_f32 v93, v93
    v_exp_f32 v94, v94
    v_exp_f32 v95, v95
    v_cvt_pk_bf16_f32 v112, v88, v89
    v_cvt_pk_bf16_f32 v113, v90, v91
    v_mfma_f32_32x32x8_bf16 v[72:87], v[52:53], v[36:37], v[72:87]
    ds_read_b64 v[54:55], v13 offset:512
    v_exp_f32 v96, v96
    v_exp_f32 v97, v97
    v_exp_f32 v98, v98
    v_exp_f32 v99, v99
    v_cvt_pk_bf16_f32 v114, v92, v93
    v_cvt_pk_bf16_f32 v115, v94, v95
    v_mfma_f32_32x32x16_bf16 v[224:239], v[68:71], v[108:111], v[224:239]
    v_exp_f32 v100, v100
    v_exp_f32 v101, v101
    v_exp_f32 v102, v102
    v_exp_f32 v103, v103
    v_cvt_pk_bf16_f32 v116, v96, v97
    v_cvt_pk_bf16_f32 v117, v98, v99
    v_cvt_pk_bf16_f32 v118, v100, v101
    v_cvt_pk_bf16_f32 v119, v102, v103
    v_mfma_f32_32x32x16_bf16 v[240:255], v[64:67], v[112:115], v[240:255]
    v_exp_f32 v72, v72
    v_exp_f32 v73, v73
    v_exp_f32 v74, v74
    v_exp_f32 v75, v75
    v_max_f32 v5, v216, v232
    v_cmp_lt_f32 vcc, s52, v5
    s_cmp_lg_u32 vcc_hi, 0
    s_cbranch_scc1 K2A_rs0
K2A_rs0_ret:
    v_mfma_f32_32x32x16_bf16 v[88:103], v[44:47], v[24:27], 0
    v_exp_f32 v76, v76
    v_exp_f32 v77, v77
    v_exp_f32 v78, v78
    v_exp_f32 v79, v79
    v_cvt_pk_bf16_f32 v104, v72, v73
    v_cvt_pk_bf16_f32 v105, v74, v75
    v_mfma_f32_32x32x8_bf16 v[88:103], v[52:53], v[38:39], v[88:103]
    v_exp_f32 v80, v80
    v_exp_f32 v81, v81
    v_exp_f32 v82, v82
    v_exp_f32 v83, v83
    v_cvt_pk_bf16_f32 v106, v76, v77
    v_cvt_pk_bf16_f32 v107, v78, v79
    v_mfma_f32_32x32x16_bf16 v[240:255], v[68:71], v[116:119], v[240:255]
    v_exp_f32 v84, v84
    v_exp_f32 v85, v85
    v_exp_f32 v86, v86
    v_exp_f32 v87, v87
    v_cvt_pk_bf16_f32 v108, v80, v81
    v_cvt_pk_bf16_f32 v109, v82, v83
    v_cvt_pk_bf16_f32 v110, v84, v85
    v_cvt_pk_bf16_f32 v111, v86, v87
    v_mfma_f32_32x32x16_bf16 v[192:207], v[56:59], v[104:107], v[192:207]
    ds_read_b64_tr_b16 v[64:65], v14 offset:512
    v_exp_f32 v88, v88
    v_exp_f32 v89, v89
    v_exp_f32 v90, v90
    v_exp_f32 v91, v91
    v_mfma_f32_32x32x16_bf16 v[72:87], v[44:47], v[28:31], 0
    ds_read_b64_tr_b16 v[66:67], v15 offset:512
    v_exp_f32 v92, v92
    v_exp_f32 v93, v93
    v_exp_f32 v94, v94
    v_exp_f32 v95, v95
    v_cvt_pk_bf16_f32 v112, v88, v89
    v_cvt_pk_bf16_f32 v113, v90, v91
    v_mfma_f32_32x32x8_bf16 v[72:87], v[52:53], v[40:41], v[72:87]
    v_exp_f32 v96, v96
    v_exp_f32 v97, v97
    v_exp_f32 v98, v98
    v_exp_f32 v99, v99
    v_cvt_pk_bf16_f32 v114, v92, v93
    v_cvt_pk_bf16_f32 v115, v94, v95
    v_mfma_f32_32x32x16_bf16 v[192:207], v[60:63], v[108:111], v[192:207]
    v_exp_f32 v100, v100
    v_exp_f32 v101, v101
    v_exp_f32 v102, v102
    v_exp_f32 v103, v103
    v_cvt_pk_bf16_f32 v116, v96, v97
    v_cvt_pk_bf16_f32 v117, v98, v99
    v_cvt_pk_bf16_f32 v118, v100, v101
    v_cvt_pk_bf16_f32 v119, v102, v103
    v_mfma_f32_32x32x16_bf16 v[208:223], v[56:59], v[112:115], v[208:223]
    ds_read_b64_tr_b16 v[68:69], v14 offset:768
    v_exp_f32 v72, v72
    v_exp_f32 v73, v73
    v_exp_f32 v74, v74
    v_exp_f32 v75, v75
    v_max_f32 v5, v248, v200
    v_cmp_lt_f32 vcc, s52, v5
    s_cmp_lg_u32 vcc_hi, 0
    s_cbranch_scc1 K2A_rs2
K2A_rs2_ret:
    v_mfma_f32_32x32x16_bf16 v[88:103], v[44:47], v[32:35], 0
    ds_read_b64_tr_b16 v[70:71], v15 offset:768
    v_exp_f32 v76, v76
    v_exp_f32 v77, v77
    v_exp_f32 v78, v78
    v_exp_f32 v79, v79
    v_cvt_pk_bf16_f32 v104, v72, v73
    v_cvt_pk_bf16_f32 v105, v74, v75
    v_mfma_f32_32x32x8_bf16 v[88:103], v[52:53], v[42:43], v[88:103]
    v_exp_f32 v80, v80
    v_exp_f32 v81, v81
    v_exp_f32 v82, v82
    v_exp_f32 v83, v83
    v_cvt_pk_bf16_f32 v106, v76, v77
    v_cvt_pk_bf16_f32 v107, v78, v79
    v_mfma_f32_32x32x16_bf16 v[208:223], v[60:63], v[116:119], v[208:223]
    v_exp_f32 v84, v84
    v_exp_f32 v85, v85
    v_exp_f32 v86, v86
    v_exp_f32 v87, v87
    v_cvt_pk_bf16_f32 v108, v80, v81
    v_cvt_pk_bf16_f32 v109, v82, v83
    v_cvt_pk_bf16_f32 v110, v84, v85
    v_cvt_pk_bf16_f32 v111, v86, v87
    v_mfma_f32_32x32x16_bf16 v[224:239], v[56:59], v[104:107], v[224:239]
    s_waitcnt lgkmcnt(0)
    v_exp_f32 v88, v88
    v_exp_f32 v89, v89
    v_exp_f32 v90, v90
    v_exp_f32 v91, v91
    v_mfma_f32_32x32x16_bf16 v[72:87], v[48:51], v[20:23], 0
    s_add_u32 s49, s49, 1
    v_exp_f32 v92, v92
    v_exp_f32 v93, v93
    v_exp_f32 v94, v94
    v_exp_f32 v95, v95
    v_cvt_pk_bf16_f32 v112, v88, v89
    v_cvt_pk_bf16_f32 v113, v90, v91
    v_mfma_f32_32x32x8_bf16 v[72:87], v[54:55], v[36:37], v[72:87]
    s_cmp_eq_u32 s49, 3
    v_exp_f32 v96, v96
    v_exp_f32 v97, v97
    v_exp_f32 v98, v98
    v_exp_f32 v99, v99
    v_cvt_pk_bf16_f32 v114, v92, v93
    v_cvt_pk_bf16_f32 v115, v94, v95
    v_mfma_f32_32x32x16_bf16 v[224:239], v[60:63], v[108:111], v[224:239]
    s_movk_i32 s53, 13312
    s_cmovk_i32 s53, 38912
    s_cmov_b32 s49, 0
    v_exp_f32 v100, v100
    v_exp_f32 v101, v101
    v_exp_f32 v102, v102
    v_exp_f32 v103, v103
    v_cvt_pk_bf16_f32 v116, v96, v97
    v_cvt_pk_bf16_f32 v117, v98, v99
    v_cvt_pk_bf16_f32 v118, v100, v101
    v_cvt_pk_bf16_f32 v119, v102, v103
    v_mfma_f32_32x32x16_bf16 v[240:255], v[56:59], v[112:115], v[240:255]
    s_cmp_eq_u32 s48, 7
    s_cbranch_scc1 K2A_nb12
    s_barrier
K2A_nb12:
    v_exp_f32 v72, v72
    v_exp_f32 v73, v73
    v_exp_f32 v74, v74
    v_exp_f32 v75, v75
    v_add_u32 v12, s53, v12
    v_add_u32 v13, s53, v13
    v_add_u32 v14, s53, v14
    v_add_u32 v15, s53, v15
    v_mfma_f32_32x32x16_bf16 v[88:103], v[48:51], v[24:27], 0
    ds_read_b128 v[44:47], v12 offset:0
    v_exp_f32 v76, v76
    v_exp_f32 v77, v77
    v_exp_f32 v78, v78
    v_exp_f32 v79, v79
    v_cvt_pk_bf16_f32 v104, v72, v73
    v_cvt_pk_bf16_f32 v105, v74, v75
    v_mfma_f32_32x32x8_bf16 v[88:103], v[54:55], v[38:39], v[88:103]
    ds_read_b64 v[52:53], v13 offset:0
    v_exp_f32 v80, v80
    v_exp_f32 v81, v81
    v_exp_f32 v82, v82
    v_exp_f32 v83, v83
    v_cvt_pk_bf16_f32 v106, v76, v77
    v_cvt_pk_bf16_f32 v107, v78, v79
    v_mfma_f32_32x32x16_bf16 v[240:255], v[60:63], v[116:119], v[240:255]
    v_exp_f32 v84, v84
    v_exp_f32 v85, v85
    v_exp_f32 v86, v86
    v_exp_f32 v87, v87
    v_cvt_pk_bf16_f32 v108, v80, v81
    v_cvt_pk_bf16_f32 v109, v82, v83
    v_cvt_pk_bf16_f32 v110, v84, v85
    v_cvt_pk_bf16_f32 v111, v86, v87
    v_mfma_f32_32x32x16_bf16 v[192:207], v[64:67], v[104:107], v[192:207]
    ds_read_b64_tr_b16 v[56:57], v14 offset:0
    v_exp_f32 v88, v88
    v_exp_f32 v89, v89
    v_exp_f32 v90, v90
    v_exp_f32 v91, v91
    v_mfma_f32_32x32x16_bf16 v[72:87], v[48:51], v[28:31], 0
    ds_read_b64_tr_b16 v[58:59], v15 offset:0
    v_exp_f32 v92, v92
    v_exp_f32 v93, v93
    v_exp_f32 v94, v94
    v_exp_f32 v95, v95
    v_cvt_pk_bf16_f32 v112, v88, v89
    v_cvt_pk_bf16_f32 v113, v90, v91
    v_mfma_f32_32x32x8_bf16 v[72:87], v[54:55], v[40:41], v[72:87]
    v_exp_f32 v96, v96
    v_exp_f32 v97, v97
    v_exp_f32 v98, v98
    v_exp_f32 v99, v99
    v_cvt_pk_bf16_f32 v114, v92, v93
    v_cvt_pk_bf16_f32 v115, v94, v95
    v_mfma_f32_32x32x16_bf16 v[192:207], v[68:71], v[108:111], v[192:207]
    v_exp_f32 v100, v100
    v_exp_f32 v101, v101
    v_exp_f32 v102, v102
    v_exp_f32 v103, v103
    v_cvt_pk_bf16_f32 v116, v96, v97
    v_cvt_pk_bf16_f32 v117, v98, v99
    v_cvt_pk_bf16_f32 v118, v100, v101
    v_cvt_pk_bf16_f32 v119, v102, v103
    v_mfma_f32_32x32x16_bf16 v[208:223], v[64:67], v[112:115], v[208:223]
    ds_read_b64_tr_b16 v[60:61], v14 offset:256
    v_exp_f32 v72, v72
    v_exp_f32 v73, v73
    v_exp_f32 v74, v74
    v_exp_f32 v75, v75
    v_mfma_f32_32x32x16_bf16 v[88:103], v[48:51], v[32:35], 0
    ds_read_b64_tr_b16 v[62:63], v15 offset:256
    v_exp_f32 v76, v76
    v_exp_f32 v77, v77
    v_exp_f32 v78, v78
    v_exp_f32 v79, v79
    v_cvt_pk_bf16_f32 v104, v72, v73
    v_cvt_pk_bf16_f32 v105, v74, v75
    v_mfma_f32_32x32x8_bf16 v[88:103], v[54:55], v[42:43], v[88:103]
    v_exp_f32 v80, v80
    v_exp_f32 v81, v81
    v_exp_f32 v82, v82
    v_exp_f32 v83, v83
    v_cvt_pk_bf16_f32 v106, v76, v77
    v_cvt_pk_bf16_f32 v107, v78, v79
    v_mfma_f32_32x32x16_bf16 v[208:223], v[68:71], v[116:119], v[208:223]
    v_exp_f32 v84, v84
    v_exp_f32 v85, v85
    v_exp_f32 v86, v86
    v_exp_f32 v87, v87
    v_cvt_pk_bf16_f32 v108, v80, v81
    v_cvt_pk_bf16_f32 v109, v82, v83
    v_cvt_pk_bf16_f32 v110, v84, v85
    v_cvt_pk_bf16_f32 v111, v86, v87
    v_mfma_f32_32x32x16_bf16 v[224:239], v[64:67], v[104:107], v[224:239]
    s_waitcnt lgkmcnt(0)
    v_exp_f32 v88, v88
    v_exp_f32 v89, v89
    v_exp_f32 v90, v90
    v_exp_f32 v91, v91
    v_mfma_f32_32x32x16_bf16 v[72:87], v[44:47], v[20:23], 0
    ds_read_b128 v[48:51], v12 offset:512
    v_exp_f32 v92, v92
    v_exp_f32 v93, v93
    v_exp_f32 v94, v94
    v_exp_f32 v95, v95
    v_cvt_pk_bf16_f32 v112, v88, v89
    v_cvt_pk_bf16_f32 v113, v90, v91
    v_mfma_f32_32x32x8_bf16 v[72:87], v[52:53], v[36:37], v[72:87]
    ds_read_b64 v[54:55], v13 offset:512
    v_exp_f32 v96, v96
    v_exp_f32 v97, v97
    v_exp_f32 v98, v98
    v_exp_f32 v99, v99
    v_cvt_pk_bf16_f32 v114, v92, v93
    v_cvt_pk_bf16_f32 v115, v94, v95
    v_mfma_f32_32x32x16_bf16 v[224:239], v[68:71], v[108:111], v[224:239]
    s_add_u32 s48, s48, 1
    s_cmp_lt_u32 s48, 8
    v_exp_f32 v100, v100
    v_exp_f32 v101, v101
    v_exp_f32 v102, v102
    v_exp_f32 v103, v103
    v_cvt_pk_bf16_f32 v116, v96, v97
    v_cvt_pk_bf16_f32 v117, v98, v99
    v_cvt_pk_bf16_f32 v118, v100, v101
    v_cvt_pk_bf16_f32 v119, v102, v103
    s_cbranch_scc1 K2A_loop
    s_setprio 2
    s_nop 0
    v_mfma_f32_32x32x16_bf16 v[240:255], v[64:67], v[112:115], v[240:255]
    v_mfma_f32_32x32x16_bf16 v[240:255], v[68:71], v[116:119], v[240:255]
K2A_comb:
    ds_write_b128 v152, v[192:195] offset:0
    ds_write_b128 v152, v[196:199] offset:1024
    ds_write_b128 v152, v[200:203] offset:2048
    ds_write_b32 v153, v16 offset:6144
    ds_write_b128 v152, v[208:211] offset:3072
    ds_write_b128 v152, v[212:215] offset:4096
    ds_write_b128 v152, v[216:219] offset:5120
    ds_write_b32 v153, v17 offset:6400
    s_cmp_lg_u32 s54, 0
    s_cbranch_scc1 K2A_nochk
    v_mul_f32 v5, 0, v192
    v_mul_f32 v6, 0, v193
    v_mul_f32 v7, 0, v194
    v_mul_f32 v8, 0, v195
    v_fmac_f32 v5, 0, v196
    v_fmac_f32 v6, 0, v197
    v_fmac_f32 v7, 0, v198
    v_fmac_f32 v8, 0, v199
    v_fmac_f32 v5, 0, v200
    v_fmac_f32 v6, 0, v201
    v_fmac_f32 v7, 0, v202
    v_fmac_f32 v8, 0, v203
    v_fmac_f32 v5, 0, v208
    v_fmac_f32 v6, 0, v209
    v_fmac_f32 v7, 0, v210
    v_fmac_f32 v8, 0, v211
    v_fmac_f32 v5, 0, v212
    v_fmac_f32 v6, 0, v213
    v_fmac_f32 v7, 0, v214
    v_fmac_f32 v8, 0, v215
    v_fmac_f32 v5, 0, v216
    v_fmac_f32 v6, 0, v217
    v_fmac_f32 v7, 0, v218
    v_fmac_f32 v8, 0, v219
    v_fmac_f32 v5, 0, v224
    v_fmac_f32 v6, 0, v225
    v_fmac_f32 v7, 0, v226
    v_fmac_f32 v8, 0, v227
    v_fmac_f32 v5, 0, v228
    v_fmac_f32 v6, 0, v229
    v_fmac_f32 v7, 0, v230
    v_fmac_f32 v8, 0, v231
    v_fmac_f32 v5, 0, v232
    v_fmac_f32 v6, 0, v233
    v_fmac_f32 v7, 0, v234
    v_fmac_f32 v8, 0, v235
    v_fmac_f32 v5, 0, v240
    v_fmac_f32 v6, 0, v241
    v_fmac_f32 v7, 0, v242
    v_fmac_f32 v8, 0, v243
    v_fmac_f32 v5, 0, v244
    v_fmac_f32 v6, 0, v245
    v_fmac_f32 v7, 0, v246
    v_fmac_f32 v8, 0, v247
    v_fmac_f32 v5, 0, v248
    v_fmac_f32 v6, 0, v249
    v_fmac_f32 v7, 0, v250
    v_fmac_f32 v8, 0, v251
    v_max3_f32 v9, v200, v216, v232
    v_max_f32 v9, v9, v248
    v_mul_f32 v9, 0x4d800000, v9
    v_fmac_f32 v5, 0, v9
    v_add_f32 v5, v5, v6
    v_add_f32 v7, v7, v8
    v_cmp_u_f32 vcc, v5, v7
    s_cbranch_vccnz K2A_fb
K2A_nochk:
    v_mov_b32 v11, 1
    s_waitcnt lgkmcnt(0)
    ds_write_b32 v157, v11
K2A_poll:
    ds_read_b32 v11, v158
    s_waitcnt lgkmcnt(0)
    v_cmp_eq_u32 vcc, 0, v11
    s_cbranch_vccnz K2A_poll
    ds_read_b32 v144, v155 offset:6144
    ds_read_b128 v[128:131], v154 offset:2048
    ds_read_b128 v[120:123], v154 offset:0
    ds_read_b128 v[124:127], v154 offset:1024
    ds_read_b32 v145, v155 offset:6400
    ds_read_b128 v[140:143], v154 offset:5120
    ds_read_b128 v[132:135], v154 offset:3072
    ds_read_b128 v[136:139], v154 offset:4096
    s_waitcnt lgkmcnt(6)
    v_max_f32 v5, v18, v144
    v_sub_f32 v6, v18, v5
    v_sub_f32 v8, v144, v5
    v_cvt_i32_f32 v6, v6
    v_cvt_i32_f32 v8, v8
    v_ldexp_f32 v5, v232, v6
    v_ldexp_f32 v10, v128, v8
    v_add_f32 v5, v5, v10
    v_mov_b32 v10, v5
    s_nop 1
    v_permlane32_swap_b32 v5, v10
    v_rcp_f32 v10, v10
    s_nop 0
    v_ldexp_f32 v6, v10, v6
    v_ldexp_f32 v8, v10, v8
    s_waitcnt lgkmcnt(4)
    v_mul_f32 v224, v224, v6
    v_mul_f32 v225, v225, v6
    v_mul_f32 v226, v226, v6
    v_mul_f32 v227, v227, v6
    v_mul_f32 v228, v228, v6
    v_mul_f32 v229, v229, v6
    v_mul_f32 v230, v230, v6
    v_mul_f32 v231, v231, v6
    v_mul_f32 v232, v232, v6
    v_mul_f32 v233, v233, v6
    v_mul_f32 v234, v234, v6
    v_mul_f32 v235, v235, v6
    v_fmac_f32 v224, v120, v8
    v_fmac_f32 v225, v121, v8
    v_fmac_f32 v226, v122, v8
    v_fmac_f32 v227, v123, v8
    v_fmac_f32 v228, v124, v8
    v_fmac_f32 v229, v125, v8
    v_fmac_f32 v230, v126, v8
    v_fmac_f32 v231, v127, v8
    v_fmac_f32 v232, v128, v8
    v_fmac_f32 v233, v129, v8
    v_fmac_f32 v234, v130, v8
    v_fmac_f32 v235, v131, v8
    v_cvt_pk_bf16_f32 v72, v224, v225
    v_cvt_pk_bf16_f32 v73, v226, v227
    v_cvt_pk_bf16_f32 v74, v228, v229
    v_cvt_pk_bf16_f32 v75, v230, v231
    buffer_store_dwordx4 v[72:75], v156, s[24:27], s77 offen sc1
    v_cvt_pk_bf16_f32 v76, v232, v233
    v_cvt_pk_bf16_f32 v77, v234, v235
    s_add_u32 s77, s77, 90112
    s_waitcnt lgkmcnt(2)
    v_max_f32 v5, v19, v145
    v_sub_f32 v6, v19, v5
    v_sub_f32 v8, v145, v5
    v_cvt_i32_f32 v6, v6
    v_cvt_i32_f32 v8, v8
    v_ldexp_f32 v5, v248, v6
    v_ldexp_f32 v10, v140, v8
    v_add_f32 v5, v5, v10
    v_mov_b32 v10, v5
    s_nop 1
    v_permlane32_swap_b32 v5, v10
    v_rcp_f32 v10, v10
    s_nop 0
    v_ldexp_f32 v6, v10, v6
    v_ldexp_f32 v8, v10, v8
    s_waitcnt lgkmcnt(0)
    v_mul_f32 v240, v240, v6
    v_mul_f32 v241, v241, v6
    v_mul_f32 v242, v242, v6
    v_mul_f32 v243, v243, v6
    v_mul_f32 v244, v244, v6
    v_mul_f32 v245, v245, v6
    v_mul_f32 v246, v246, v6
    v_mul_f32 v247, v247, v6
    v_mul_f32 v248, v248, v6
    v_mul_f32 v249, v249, v6
    v_mul_f32 v250, v250, v6
    v_mul_f32 v251, v251, v6
    v_fmac_f32 v240, v132, v8
    v_fmac_f32 v241, v133, v8
    v_fmac_f32 v242, v134, v8
    v_fmac_f32 v243, v135, v8
    v_fmac_f32 v244, v136, v8
    v_fmac_f32 v245, v137, v8
    v_fmac_f32 v246, v138, v8
    v_fmac_f32 v247, v139, v8
    v_fmac_f32 v248, v140, v8
    v_fmac_f32 v249, v141, v8
    v_fmac_f32 v250, v142, v8
    v_fmac_f32 v251, v143, v8
    v_cvt_pk_bf16_f32 v88, v240, v241
    v_cvt_pk_bf16_f32 v89, v242, v243
    v_cvt_pk_bf16_f32 v90, v244, v245
    v_cvt_pk_bf16_f32 v91, v246, v247
    buffer_store_dwordx4 v[88:91], v156, s[24:27], s77 offen sc1
    v_cvt_pk_bf16_f32 v78, v248, v249
    v_cvt_pk_bf16_f32 v79, v250, v251
    s_mov_b32 exec_hi, 0
    buffer_store_dwordx4 v[76:79], v159, s[24:27], s78 offen sc1
    v_mov_b32 v5, s3
    v_mov_b32 v6, 0
    s_mov_b64 exec, 1
    s_waitcnt vmcnt(0)
    buffer_store_dword v5, v6, s[24:27], s76 offen sc1
    s_mov_b64 exec, -1
    s_endpgm
K2A_rs0:
    v_mov_b32 v5, v216
    v_mov_b32 v6, v216
    s_nop 1
    v_permlane32_swap_b32 v5, v6
    v_frexp_exp_i32_f32 v7, v6
    v_cvt_f32_i32 v7, v7
    v_add_f32 v7, 0x42a00000, v7
    v_cmp_lt_f32 vcc, s52, v6
    v_mov_b32 v8, v17
    s_nop 0
    v_cndmask_b32 v7, 0, v7, vcc
    v_add_f32 v7, v7, v8
    v_cvt_pk_bf16_f32 v9, v7, v7
    v_and_b32 v9, 0xffff0000, v9
    v_sub_f32 v7, v7, v9
    v_cvt_pk_bf16_f32 v7, -v9, -v7
    v_and_b32 v17, 0xffff0000, v7
    v_sub_f32 v17, v9, v17
    s_mov_b32 exec_lo, 0
    v_mov_b32 v38, v7
    s_mov_b32 exec_lo, -1
    v_sub_f32 v8, v8, v17
    v_cvt_i32_f32 v8, v8
    v_ldexp_f32 v208, v208, v8
    v_ldexp_f32 v209, v209, v8
    v_ldexp_f32 v210, v210, v8
    v_ldexp_f32 v211, v211, v8
    v_ldexp_f32 v212, v212, v8
    v_ldexp_f32 v213, v213, v8
    v_ldexp_f32 v214, v214, v8
    v_ldexp_f32 v215, v215, v8
    v_ldexp_f32 v216, v216, v8
    v_ldexp_f32 v217, v217, v8
    v_ldexp_f32 v218, v218, v8
    v_ldexp_f32 v219, v219, v8
    v_ldexp_f32 v220, v220, v8
    v_ldexp_f32 v221, v221, v8
    v_ldexp_f32 v222, v222, v8
    v_ldexp_f32 v223, v223, v8
    v_mov_b32 v5, v232
    v_mov_b32 v6, v232
    s_nop 1
    v_permlane32_swap_b32 v5, v6
    v_frexp_exp_i32_f32 v7, v6
    v_cvt_f32_i32 v7, v7
    v_add_f32 v7, 0x42a00000, v7
    v_cmp_lt_f32 vcc, s52, v6
    v_mov_b32 v8, v18
    s_nop 0
    v_cndmask_b32 v7, 0, v7, vcc
    v_add_f32 v7, v7, v8
    v_cvt_pk_bf16_f32 v9, v7, v7
    v_and_b32 v9, 0xffff0000, v9
    v_sub_f32 v7, v7, v9
    v_cvt_pk_bf16_f32 v7, -v9, -v7
    v_and_b32 v18, 0xffff0000, v7
    v_sub_f32 v18, v9, v18
    s_mov_b32 exec_lo, 0
    v_mov_b32 v40, v7
    s_mov_b32 exec_lo, -1
    v_sub_f32 v8, v8, v18
    v_cvt_i32_f32 v8, v8
    v_ldexp_f32 v224, v224, v8
    v_ldexp_f32 v225, v225, v8
    v_ldexp_f32 v226, v226, v8
    v_ldexp_f32 v227, v227, v8
    v_ldexp_f32 v228, v228, v8
    v_ldexp_f32 v229, v229, v8
    v_ldexp_f32 v230, v230, v8
    v_ldexp_f32 v231, v231, v8
    v_ldexp_f32 v232, v232, v8
    v_ldexp_f32 v233, v233, v8
    v_ldexp_f32 v234, v234, v8
    v_ldexp_f32 v235, v235, v8
    v_ldexp_f32 v236, v236, v8
    v_ldexp_f32 v237, v237, v8
    v_ldexp_f32 v238, v238, v8
    v_ldexp_f32 v239, v239, v8
    s_nop 1
    s_branch K2A_rs0_ret
K2A_rs2:
    v_mov_b32 v5, v248
    v_mov_b32 v6, v248
    s_nop 1
    v_permlane32_swap_b32 v5, v6
    v_frexp_exp_i32_f32 v7, v6
    v_cvt_f32_i32 v7, v7
    v_add_f32 v7, 0x42a00000, v7
    v_cmp_lt_f32 vcc, s52, v6
    v_mov_b32 v8, v19
    s_nop 0
    v_cndmask_b32 v7, 0, v7, vcc
    v_add_f32 v7, v7, v8
    v_cvt_pk_bf16_f32 v9, v7, v7
    v_and_b32 v9, 0xffff0000, v9
    v_sub_f32 v7, v7, v9
    v_cvt_pk_bf16_f32 v7, -v9, -v7
    v_and_b32 v19, 0xffff0000, v7
    v_sub_f32 v19, v9, v19
    s_mov_b32 exec_lo, 0
    v_mov_b32 v42, v7
    s_mov_b32 exec_lo, -1
    v_sub_f32 v8, v8, v19
    v_cvt_i32_f32 v8, v8
    v_ldexp_f32 v240, v240, v8
    v_ldexp_f32 v241, v241, v8
    v_ldexp_f32 v242, v242, v8
    v_ldexp_f32 v243, v243, v8
    v_ldexp_f32 v244, v244, v8
    v_ldexp_f32 v245, v245, v8
    v_ldexp_f32 v246, v246, v8
    v_ldexp_f32 v247, v247, v8
    v_ldexp_f32 v248, v248, v8
    v_ldexp_f32 v249, v249, v8
    v_ldexp_f32 v250, v250, v8
    v_ldexp_f32 v251, v251, v8
    v_ldexp_f32 v252, v252, v8
    v_ldexp_f32 v253, v253, v8
    v_ldexp_f32 v254, v254, v8
    v_ldexp_f32 v255, v255, v8
    v_mov_b32 v5, v200
    v_mov_b32 v6, v200
    s_nop 1
    v_permlane32_swap_b32 v5, v6
    v_frexp_exp_i32_f32 v7, v6
    v_cvt_f32_i32 v7, v7
    v_add_f32 v7, 0x42a00000, v7
    v_cmp_lt_f32 vcc, s52, v6
    v_mov_b32 v8, v16
    s_nop 0
    v_cndmask_b32 v7, 0, v7, vcc
    v_add_f32 v7, v7, v8
    v_cvt_pk_bf16_f32 v9, v7, v7
    v_and_b32 v9, 0xffff0000, v9
    v_sub_f32 v7, v7, v9
    v_cvt_pk_bf16_f32 v7, -v9, -v7
    v_and_b32 v16, 0xffff0000, v7
    v_sub_f32 v16, v9, v16
    s_mov_b32 exec_lo, 0
    v_mov_b32 v36, v7
    s_mov_b32 exec_lo, -1
    v_sub_f32 v8, v8, v16
    v_cvt_i32_f32 v8, v8
    v_ldexp_f32 v192, v192, v8
    v_ldexp_f32 v193, v193, v8
    v_ldexp_f32 v194, v194, v8
    v_ldexp_f32 v195, v195, v8
    v_ldexp_f32 v196, v196, v8
    v_ldexp_f32 v197, v197, v8
    v_ldexp_f32 v198, v198, v8
    v_ldexp_f32 v199, v199, v8
    v_ldexp_f32 v200, v200, v8
    v_ldexp_f32 v201, v201, v8
    v_ldexp_f32 v202, v202, v8
    v_ldexp_f32 v203, v203, v8
    v_ldexp_f32 v204, v204, v8
    v_ldexp_f32 v205, v205, v8
    v_ldexp_f32 v206, v206, v8
    v_ldexp_f32 v207, v207, v8
    s_nop 1
    s_branch K2A_rs2_ret
K2A_fb:
    s_mul_i32 s48, s12, 6656
    s_add_u32 s48, s48, 125952
    s_movk_i32 s49, 12288
    s_waitcnt lgkmcnt(0)
    v_lshlrev_b32 v5, 2, v4
    v_xor_b32 v5, v5, v3
    v_lshlrev_b32 v5, 4, v5
    v_lshl_add_u32 v12, v4, 10, v5
    v_add_u32 v12, s48, v12
    v_xor_b32 v5, 8, v3
    s_lshl_b32 s70, s32, 3
    s_add_u32 s70, s70, s48
    s_add_u32 s70, s70, 2048
    v_lshl_add_u32 v5, v5, 4, s70
    v_lshl_add_u32 v6, v3, 4, s49
    s_mov_b32 s66, -1
    s_mov_b32 s67, 0
    v_cndmask_b32 v13, v6, v5, s[66:67]
    v_bfe_u32 v7, v2, 2, 2
    v_lshl_add_u32 v7, v4, 2, v7
    v_bfe_u32 v5, v2, 4, 1
    v_bfe_u32 v6, v2, 1, 1
    v_lshl_add_u32 v5, v5, 1, v6
    s_mov_b32 s66, 0xeeee0000
    s_mov_b32 s67, 0xeeee0000
    v_cndmask_b32 v5, v5, 3, s[66:67]
    v_and_b32 v8, 1, v2
    v_cndmask_b32 v8, v8, v6, s[66:67]
    s_mul_i32 s68, s32, 0x11110000
    s_mov_b32 s69, s68
    v_cndmask_b32 v8, v8, 1, s[68:69]
    v_lshlrev_b32 v6, 2, v5
    v_xor_b32 v6, v6, v7
    v_lshlrev_b32 v6, 4, v6
    v_lshl_add_u32 v6, v8, 3, v6
    s_add_u32 s70, s48, 3072
    v_lshl_add_u32 v5, v5, 10, s70
    v_mov_b32 v8, s49
    v_cndmask_b32 v5, v5, v8, s[66:67]
    v_add_u32 v14, v6, v5
    v_xor_b32 v15, 0x80, v14
    v_lshlrev_b32 v11, 4, v2
    s_mov_b32 exec_lo, 0
    v_mov_b32 v36, 0
    v_mov_b32 v38, 0
    v_mov_b32 v40, 0
    v_mov_b32 v42, 0
    s_mov_b32 exec_lo, -1
    v_mov_b32 v16, 0xff800000
    v_mov_b32 v192, 0
    v_mov_b32 v193, 0
    v_mov_b32 v194, 0
    v_mov_b32 v195, 0
    v_mov_b32 v196, 0
    v_mov_b32 v197, 0
    v_mov_b32 v198, 0
    v_mov_b32 v199, 0
    v_mov_b32 v200, 0
    v_mov_b32 v201, 0
    v_mov_b32 v202, 0
    v_mov_b32 v203, 0
    v_mov_b32 v204, 0
    v_mov_b32 v205, 0
    v_mov_b32 v206, 0
    v_mov_b32 v207, 0
    v_mov_b32 v17, 0xff800000
    v_mov_b32 v208, 0
    v_mov_b32 v209, 0
    v_mov_b32 v210, 0
    v_mov_b32 v211, 0
    v_mov_b32 v212, 0
    v_mov_b32 v213, 0
    v_mov_b32 v214, 0
    v_mov_b32 v215, 0
    v_mov_b32 v216, 0
    v_mov_b32 v217, 0
    v_mov_b32 v218, 0
    v_mov_b32 v219, 0
    v_mov_b32 v220, 0
    v_mov_b32 v221, 0
    v_mov_b32 v222, 0
    v_mov_b32 v223, 0
    v_mov_b32 v18, 0xff800000
    v_mov_b32 v224, 0
    v_mov_b32 v225, 0
    v_mov_b32 v226, 0
    v_mov_b32 v227, 0
    v_mov_b32 v228, 0
    v_mov_b32 v229, 0
    v_mov_b32 v230, 0
    v_mov_b32 v231, 0
    v_mov_b32 v232, 0
    v_mov_b32 v233, 0
    v_mov_b32 v234, 0
    v_mov_b32 v235, 0
    v_mov_b32 v236, 0
    v_mov_b32 v237, 0
    v_mov_b32 v238, 0
    v_mov_b32 v239, 0
    v_mov_b32 v19, 0xff800000
    v_mov_b32 v240, 0
    v_mov_b32 v241, 0
    v_mov_b32 v242, 0
    v_mov_b32 v243, 0
    v_mov_b32 v244, 0
    v_mov_b32 v245, 0
    v_mov_b32 v246, 0
    v_mov_b32 v247, 0
    v_mov_b32 v248, 0
    v_mov_b32 v249, 0
    v_mov_b32 v250, 0
    v_mov_b32 v251, 0
    v_mov_b32 v252, 0
    v_mov_b32 v253, 0
    v_mov_b32 v254, 0
    v_mov_b32 v255, 0
    s_mov_b32 s54, 0
K2A_fb_pass:
    s_lshl_b32 s15, s36, 4
    s_add_u32 s56, s34, 80
    s_lshl_b32 s56, s56, 5
    s_add_u32 s56, s56, s15
    s_lshl_b32 s56, s56, 10
    s_add_u32 s57, s33, 80
    s_lshl_b32 s57, s57, 5
    s_add_u32 s57, s57, s15
    s_lshl_b32 s57, s57, 10
    s_add_u32 s58, s34, 160
    s_lshl_b32 s58, s58, 5
    s_add_u32 s58, s58, s15
    s_lshl_b32 s58, s58, 10
    s_add_u32 s59, s33, 160
    s_lshl_b32 s59, s59, 5
    s_add_u32 s59, s59, s15
    s_lshl_b32 s59, s59, 10
    s_mov_b32 s55, 0
K2A_fb_blk:
    s_add_u32 m0, s48, 0
    s_add_u32 s15, s56, 0
    buffer_load_dwordx4 v11, s[24:27], s15 offen sc1 lds
    s_add_u32 m0, s48, 1024
    s_add_u32 s15, s56, 32768
    buffer_load_dwordx4 v11, s[24:27], s15 offen sc1 lds
    s_add_u32 m0, s48, 2048
    s_add_u32 s15, s57, 0
    buffer_load_dwordx4 v11, s[24:27], s15 offen sc1 lds
    s_add_u32 m0, s48, 3072
    s_add_u32 s15, s58, 0
    buffer_load_dwordx4 v11, s[24:27], s15 offen sc1 lds
    s_add_u32 m0, s48, 4096
    s_add_u32 s15, s58, 32768
    buffer_load_dwordx4 v11, s[24:27], s15 offen sc1 lds
    s_add_u32 m0, s48, 5120
    s_add_u32 s15, s59, 0
    buffer_load_dwordx4 v11, s[24:27], s15 offen sc1 lds
    s_add_u32 s56, s56, 1024
    s_add_u32 s57, s57, 1024
    s_add_u32 s58, s58, 1024
    s_add_u32 s59, s59, 1024
    s_waitcnt vmcnt(0) lgkmcnt(0)
    ds_read_b128 v[44:47], v12 offset:0
    ds_read_b64 v[52:53], v13 offset:0
    ds_read_b128 v[48:51], v12 offset:512
    ds_read_b64 v[54:55], v13 offset:512
    ds_read_b64_tr_b16 v[56:57], v14 offset:0
    ds_read_b64_tr_b16 v[58:59], v15 offset:0
    ds_read_b64_tr_b16 v[60:61], v14 offset:256
    ds_read_b64_tr_b16 v[62:63], v15 offset:256
    ds_read_b64_tr_b16 v[64:65], v14 offset:512
    ds_read_b64_tr_b16 v[66:67], v15 offset:512
    ds_read_b64_tr_b16 v[68:69], v14 offset:768
    ds_read_b64_tr_b16 v[70:71], v15 offset:768
    s_waitcnt lgkmcnt(0)
    s_mov_b32 s60, 0
K2A_fb_kt:
    v_mfma_f32_32x32x16_bf16 v[72:87], v[44:47], v[20:23], 0
    v_mfma_f32_32x32x8_bf16 v[72:87], v[52:53], v[36:37], v[72:87]
    s_nop 15
    s_cmp_eq_u32 s54, 0
    s_cbranch_scc0 K2A_fb_e0
    v_max3_f32 v16, v16, v72, v73
    v_max3_f32 v16, v16, v74, v75
    v_max3_f32 v16, v16, v76, v77
    v_max3_f32 v16, v16, v78, v79
    v_max3_f32 v16, v16, v80, v81
    v_max3_f32 v16, v16, v82, v83
    v_max3_f32 v16, v16, v84, v85
    v_max3_f32 v16, v16, v86, v87
    s_branch K2A_fb_n0
K2A_fb_e0:
    v_exp_f32 v72, v72
    v_exp_f32 v73, v73
    v_exp_f32 v74, v74
    v_exp_f32 v75, v75
    v_exp_f32 v76, v76
    v_exp_f32 v77, v77
    v_exp_f32 v78, v78
    v_exp_f32 v79, v79
    v_exp_f32 v80, v80
    v_exp_f32 v81, v81
    v_exp_f32 v82, v82
    v_exp_f32 v83, v83
    v_exp_f32 v84, v84
    v_exp_f32 v85, v85
    v_exp_f32 v86, v86
    v_exp_f32 v87, v87
    s_nop 0
    v_cvt_pk_bf16_f32 v104, v72, v73
    v_cvt_pk_bf16_f32 v105, v74, v75
    v_cvt_pk_bf16_f32 v106, v76, v77
    v_cvt_pk_bf16_f32 v107, v78, v79
    v_cvt_pk_bf16_f32 v108, v80, v81
    v_cvt_pk_bf16_f32 v109, v82, v83
    v_cvt_pk_bf16_f32 v110, v84, v85
    v_cvt_pk_bf16_f32 v111, v86, v87
    s_nop 1
    v_mfma_f32_32x32x16_bf16 v[192:207], v[56:59], v[104:107], v[192:207]
    v_mfma_f32_32x32x16_bf16 v[192:207], v[60:63], v[108:111], v[192:207]
K2A_fb_n0:
    v_mfma_f32_32x32x16_bf16 v[72:87], v[44:47], v[24:27], 0
    v_mfma_f32_32x32x8_bf16 v[72:87], v[52:53], v[38:39], v[72:87]
    s_nop 15
    s_cmp_eq_u32 s54, 0
    s_cbranch_scc0 K2A_fb_e1
    v_max3_f32 v17, v17, v72, v73
    v_max3_f32 v17, v17, v74, v75
    v_max3_f32 v17, v17, v76, v77
    v_max3_f32 v17, v17, v78, v79
    v_max3_f32 v17, v17, v80, v81
    v_max3_f32 v17, v17, v82, v83
    v_max3_f32 v17, v17, v84, v85
    v_max3_f32 v17, v17, v86, v87
    s_branch K2A_fb_n1
K2A_fb_e1:
    v_exp_f32 v72, v72
    v_exp_f32 v73, v73
    v_exp_f32 v74, v74
    v_exp_f32 v75, v75
    v_exp_f32 v76, v76
    v_exp_f32 v77, v77
    v_exp_f32 v78, v78
    v_exp_f32 v79, v79
    v_exp_f32 v80, v80
    v_exp_f32 v81, v81
    v_exp_f32 v82, v82
    v_exp_f32 v83, v83
    v_exp_f32 v84, v84
    v_exp_f32 v85, v85
    v_exp_f32 v86, v86
    v_exp_f32 v87, v87
    s_nop 0
    v_cvt_pk_bf16_f32 v104, v72, v73
    v_cvt_pk_bf16_f32 v105, v74, v75
    v_cvt_pk_bf16_f32 v106, v76, v77
    v_cvt_pk_bf16_f32 v107, v78, v79
    v_cvt_pk_bf16_f32 v108, v80, v81
    v_cvt_pk_bf16_f32 v109, v82, v83
    v_cvt_pk_bf16_f32 v110, v84, v85
    v_cvt_pk_bf16_f32 v111, v86, v87
    s_nop 1
    v_mfma_f32_32x32x16_bf16 v[208:223], v[56:59], v[104:107], v[208:223]
    v_mfma_f32_32x32x16_bf16 v[208:223], v[60:63], v[108:111], v[208:223]
K2A_fb_n1:
    v_mfma_f32_32x32x16_bf16 v[72:87], v[44:47], v[28:31], 0
    v_mfma_f32_32x32x8_bf16 v[72:87], v[52:53], v[40:41], v[72:87]
    s_nop 15
    s_cmp_eq_u32 s54, 0
    s_cbranch_scc0 K2A_fb_e2
    v_max3_f32 v18, v18, v72, v73
    v_max3_f32 v18, v18, v74, v75
    v_max3_f32 v18, v18, v76, v77
    v_max3_f32 v18, v18, v78, v79
    v_max3_f32 v18, v18, v80, v81
    v_max3_f32 v18, v18, v82, v83
    v_max3_f32 v18, v18, v84, v85
    v_max3_f32 v18, v18, v86, v87
    s_branch K2A_fb_n2
K2A_fb_e2:
    v_exp_f32 v72, v72
    v_exp_f32 v73, v73
    v_exp_f32 v74, v74
    v_exp_f32 v75, v75
    v_exp_f32 v76, v76
    v_exp_f32 v77, v77
    v_exp_f32 v78, v78
    v_exp_f32 v79, v79
    v_exp_f32 v80, v80
    v_exp_f32 v81, v81
    v_exp_f32 v82, v82
    v_exp_f32 v83, v83
    v_exp_f32 v84, v84
    v_exp_f32 v85, v85
    v_exp_f32 v86, v86
    v_exp_f32 v87, v87
    s_nop 0
    v_cvt_pk_bf16_f32 v104, v72, v73
    v_cvt_pk_bf16_f32 v105, v74, v75
    v_cvt_pk_bf16_f32 v106, v76, v77
    v_cvt_pk_bf16_f32 v107, v78, v79
    v_cvt_pk_bf16_f32 v108, v80, v81
    v_cvt_pk_bf16_f32 v109, v82, v83
    v_cvt_pk_bf16_f32 v110, v84, v85
    v_cvt_pk_bf16_f32 v111, v86, v87
    s_nop 1
    v_mfma_f32_32x32x16_bf16 v[224:239], v[56:59], v[104:107], v[224:239]
    v_mfma_f32_32x32x16_bf16 v[224:239], v[60:63], v[108:111], v[224:239]
K2A_fb_n2:
    v_mfma_f32_32x32x16_bf16 v[72:87], v[44:47], v[32:35], 0
    v_mfma_f32_32x32x8_bf16 v[72:87], v[52:53], v[42:43], v[72:87]
    s_nop 15
    s_cmp_eq_u32 s54, 0
    s_cbranch_scc0 K2A_fb_e3
    v_max3_f32 v19, v19, v72, v73
    v_max3_f32 v19, v19, v74, v75
    v_max3_f32 v19, v19, v76, v77
    v_max3_f32 v19, v19, v78, v79
    v_max3_f32 v19, v19, v80, v81
    v_max3_f32 v19, v19, v82, v83
    v_max3_f32 v19, v19, v84, v85
    v_max3_f32 v19, v19, v86, v87
    s_branch K2A_fb_n3
K2A_fb_e3:
    v_exp_f32 v72, v72
    v_exp_f32 v73, v73
    v_exp_f32 v74, v74
    v_exp_f32 v75, v75
    v_exp_f32 v76, v76
    v_exp_f32 v77, v77
    v_exp_f32 v78, v78
    v_exp_f32 v79, v79
    v_exp_f32 v80, v80
    v_exp_f32 v81, v81
    v_exp_f32 v82, v82
    v_exp_f32 v83, v83
    v_exp_f32 v84, v84
    v_exp_f32 v85, v85
    v_exp_f32 v86, v86
    v_exp_f32 v87, v87
    s_nop 0
    v_cvt_pk_bf16_f32 v104, v72, v73
    v_cvt_pk_bf16_f32 v105, v74, v75
    v_cvt_pk_bf16_f32 v106, v76, v77
    v_cvt_pk_bf16_f32 v107, v78, v79
    v_cvt_pk_bf16_f32 v108, v80, v81
    v_cvt_pk_bf16_f32 v109, v82, v83
    v_cvt_pk_bf16_f32 v110, v84, v85
    v_cvt_pk_bf16_f32 v111, v86, v87
    s_nop 1
    v_mfma_f32_32x32x16_bf16 v[240:255], v[56:59], v[104:107], v[240:255]
    v_mfma_f32_32x32x16_bf16 v[240:255], v[60:63], v[108:111], v[240:255]
K2A_fb_n3:
    v_mov_b32 v44, v48
    v_mov_b32 v45, v49
    v_mov_b32 v46, v50
    v_mov_b32 v47, v51
    v_mov_b32 v52, v54
    v_mov_b32 v53, v55
    v_mov_b32 v56, v64
    v_mov_b32 v57, v65
    v_mov_b32 v58, v66
    v_mov_b32 v59, v67
    v_mov_b32 v60, v68
    v_mov_b32 v61, v69
    v_mov_b32 v62, v70
    v_mov_b32 v63, v71
    s_add_u32 s60, s60, 1
    s_cmp_lt_u32 s60, 2
    s_cbranch_scc1 K2A_fb_kt
    s_add_u32 s55, s55, 1
    s_cmp_lt_u32 s55, 16
    s_cbranch_scc1 K2A_fb_blk
    s_nop 15
    s_cmp_eq_u32 s54, 0
    s_cbranch_scc0 K2A_comb
    v_mov_b32 v5, v16
    v_mov_b32 v6, v16
    s_nop 1
    v_permlane32_swap_b32 v5, v6
    v_max_f32 v5, v5, v6
    v_rndne_f32 v5, v5
    v_cvt_pk_bf16_f32 v6, v5, v5
    v_and_b32 v6, 0xffff0000, v6
    v_sub_f32 v7, v5, v6
    v_cvt_pk_bf16_f32 v8, -v6, -v7
    v_and_b32 v7, 0xffff0000, v8
    v_sub_f32 v16, v6, v7
    s_mov_b32 exec_lo, 0
    v_mov_b32 v36, v8
    s_mov_b32 exec_lo, -1
    v_mov_b32 v5, v17
    v_mov_b32 v6, v17
    s_nop 1
    v_permlane32_swap_b32 v5, v6
    v_max_f32 v5, v5, v6
    v_rndne_f32 v5, v5
    v_cvt_pk_bf16_f32 v6, v5, v5
    v_and_b32 v6, 0xffff0000, v6
    v_sub_f32 v7, v5, v6
    v_cvt_pk_bf16_f32 v8, -v6, -v7
    v_and_b32 v7, 0xffff0000, v8
    v_sub_f32 v17, v6, v7
    s_mov_b32 exec_lo, 0
    v_mov_b32 v38, v8
    s_mov_b32 exec_lo, -1
    v_mov_b32 v5, v18
    v_mov_b32 v6, v18
    s_nop 1
    v_permlane32_swap_b32 v5, v6
    v_max_f32 v5, v5, v6
    v_rndne_f32 v5, v5
    v_cvt_pk_bf16_f32 v6, v5, v5
    v_and_b32 v6, 0xffff0000, v6
    v_sub_f32 v7, v5, v6
    v_cvt_pk_bf16_f32 v8, -v6, -v7
    v_and_b32 v7, 0xffff0000, v8
    v_sub_f32 v18, v6, v7
    s_mov_b32 exec_lo, 0
    v_mov_b32 v40, v8
    s_mov_b32 exec_lo, -1
    v_mov_b32 v5, v19
    v_mov_b32 v6, v19
    s_nop 1
    v_permlane32_swap_b32 v5, v6
    v_max_f32 v5, v5, v6
    v_rndne_f32 v5, v5
    v_cvt_pk_bf16_f32 v6, v5, v5
    v_and_b32 v6, 0xffff0000, v6
    v_sub_f32 v7, v5, v6
    v_cvt_pk_bf16_f32 v8, -v6, -v7
    v_and_b32 v7, 0xffff0000, v8
    v_sub_f32 v19, v6, v7
    s_mov_b32 exec_lo, 0
    v_mov_b32 v42, v8
    s_mov_b32 exec_lo, -1
    s_mov_b32 s54, 1
    s_branch K2A_fb_pass
K2_G:
    s_sub_u32 s12, s12, 4
    s_lshl_b32 s64, s35, 2
    s_add_u32 s64, s64, s12
    s_mov_b32 s65, s36
    v_lshrrev_b32 v5, 3, v2
    v_lshrrev_b32 v6, 4, v2
    v_and_b32 v7, 7, v2
    v_and_b32 v8, 15, v2
    v_lshlrev_b32 v9, 2, v6
    v_xor_b32 v8, v8, v9
    v_mul_u32_u24 v9, 1280, v5
    v_xor_b32 v10, 0, v6
    v_xor_b32 v10, v10, v7
    v_lshl_add_u32 v10, v10, 4, v9
    v_add_u32 v12, 0, v10
    v_xor_b32 v10, 4, v6
    v_xor_b32 v10, v10, v7
    v_lshl_add_u32 v10, v10, 4, v9
    v_add_u32 v13, 9216, v10
    v_xor_b32 v10, 0, v6
    v_xor_b32 v10, v10, v7
    v_lshl_add_u32 v10, v10, 4, v9
    v_add_u32 v14, 18432, v10
    v_xor_b32 v10, 4, v6
    v_xor_b32 v10, v10, v7
    v_lshl_add_u32 v10, v10, 4, v9
    v_add_u32 v15, 27648, v10
    v_mul_u32_u24 v9, 3840, v6
    v_lshl_add_u32 v9, v8, 4, v9
    v_add_u32 v16, 0, v9
    v_add_u32 v17, 14336, v9
    v_add_u32 v18, 28672, v9
    v_add_u32 v19, 43008, v9
    s_lshl_b32 s37, s35, 7
    s_lshl_b32 s15, s12, 5
    s_add_u32 s37, s37, s15
    s_mul_i32 s37, s37, 1280
    s_mul_i32 s38, s12, 61440
    s_lshl_b32 s15, s36, 8
    s_add_u32 s38, s38, s15
    s_lshl_b32 s40, s12, 12
    s_waitcnt lgkmcnt(0)
    s_mov_b32 s16, s62
    s_and_b32 s17, s63, 0xffff
    s_mov_b32 s18, 2621440
    s_mov_b32 s19, 0x00020000
    s_mov_b32 s20, s6
    s_and_b32 s21, s7, 0xffff
    s_mov_b32 s22, 2457600
    s_mov_b32 s23, 0x00020000
    s_mul_i32 s56, s14, 1
    s_lshr_b32 s15, s2, 6
    s_mul_i32 s15, s15, 0
    s_add_u32 s56, s56, s15
    s_mul_hi_u32 s15, s56, 0x1999999A
    s_mul_i32 s15, s15, 10
    s_sub_u32 s56, s56, s15
    s_add_u32 s57, s56, 0
    s_cmp_ge_u32 s57, 10
    s_cselect_b32 s15, 10, 0
    s_sub_u32 s57, s57, s15
    s_add_u32 m0, s40, 0
    s_lshl_b32 s15, s57, 7
    s_add_u32 s15, s37, s15
    buffer_load_dwordx4 v12, s[16:19], s15 offen offset:0 lds
    buffer_load_dwordx4 v13, s[16:19], s15 offen offset:1024 lds
    buffer_load_dwordx4 v14, s[16:19], s15 offen offset:2048 lds
    buffer_load_dwordx4 v15, s[16:19], s15 offen offset:3072 lds
    s_add_u32 m0, s40, 81920
    s_mul_i32 s15, s57, 245760
    s_add_u32 s15, s38, s15
    buffer_load_dwordx4 v16, s[20:23], s15 offen offset:0 lds
    buffer_load_dwordx4 v17, s[20:23], s15 offen offset:1024 lds
    buffer_load_dwordx4 v18, s[20:23], s15 offen offset:2048 lds
    buffer_load_dwordx4 v19, s[20:23], s15 offen offset:3072 lds
    s_add_u32 s57, s56, 1
    s_cmp_ge_u32 s57, 10
    s_cselect_b32 s15, 10, 0
    s_sub_u32 s57, s57, s15
    s_add_u32 m0, s40, 16384
    s_lshl_b32 s15, s57, 7
    s_add_u32 s15, s37, s15
    buffer_load_dwordx4 v12, s[16:19], s15 offen offset:0 lds
    buffer_load_dwordx4 v13, s[16:19], s15 offen offset:1024 lds
    buffer_load_dwordx4 v14, s[16:19], s15 offen offset:2048 lds
    buffer_load_dwordx4 v15, s[16:19], s15 offen offset:3072 lds
    s_add_u32 m0, s40, 98304
    s_mul_i32 s15, s57, 245760
    s_add_u32 s15, s38, s15
    buffer_load_dwordx4 v16, s[20:23], s15 offen offset:0 lds
    buffer_load_dwordx4 v17, s[20:23], s15 offen offset:1024 lds
    buffer_load_dwordx4 v18, s[20:23], s15 offen offset:2048 lds
    buffer_load_dwordx4 v19, s[20:23], s15 offen offset:3072 lds
    s_mov_b32 s24, s10
    s_and_b32 s25, s11, 0xffff
    s_mov_b32 s26, 33554432
    s_mov_b32 s27, 0x00020000
    s_mov_b32 s28, s100
    s_and_b32 s29, s101, 0xffff
    s_mov_b32 s30, 256
    s_mov_b32 s31, 0x00020000
    s_or_b32 s15, s2, s12
    s_cmp_eq_u32 s15, 0
    s_cbranch_scc0 P1L_nn
    s_memrealtime s[48:49]
    v_mov_b32 v10, 0
    s_waitcnt lgkmcnt(0)
    s_or_b32 s15, s48, 1
    v_mov_b32 v9, s15
    s_mov_b64 exec, 1
    buffer_store_dword v9, v10, s[28:31], 0 offen sc1
    s_mov_b64 exec, -1
P1L_nn:
    s_lshl_b32 s41, s35, 7
    s_lshl_b32 s15, s36, 3
    s_add_u32 s41, s41, s15
    s_lshl_b32 s15, s12, 1
    s_add_u32 s41, s41, s15
    s_mul_i32 s42, s41, 1280
    v_mul_u32_u24 v20, 1280, v4
    v_lshl_add_u32 v20, v3, 4, v20
    v_mov_b32 v56, 0
    v_mov_b32 v57, 0
    v_mov_b32 v58, 0
    v_mov_b32 v59, 0
    v_mov_b32 v32, 0
    v_mov_b32 v33, 0
    v_mov_b32 v34, 0
    v_mov_b32 v35, 0
    s_setprio 1
    s_waitcnt vmcnt(8)
    s_barrier
    s_add_u32 s57, s56, 2
    s_cmp_ge_u32 s57, 10
    s_cselect_b32 s15, 10, 0
    s_sub_u32 s57, s57, s15
    s_add_u32 m0, s40, 32768
    s_lshl_b32 s15, s57, 7
    s_add_u32 s15, s37, s15
    buffer_load_dwordx4 v12, s[16:19], s15 offen offset:0 lds
    buffer_load_dwordx4 v13, s[16:19], s15 offen offset:1024 lds
    buffer_load_dwordx4 v14, s[16:19], s15 offen offset:2048 lds
    buffer_load_dwordx4 v15, s[16:19], s15 offen offset:3072 lds
    s_add_u32 m0, s40, 114688
    s_mul_i32 s15, s57, 245760
    s_add_u32 s15, s38, s15
    buffer_load_dwordx4 v16, s[20:23], s15 offen offset:0 lds
    buffer_load_dwordx4 v17, s[20:23], s15 offen offset:1024 lds
    buffer_load_dwordx4 v18, s[20:23], s15 offen offset:2048 lds
    buffer_load_dwordx4 v19, s[20:23], s15 offen offset:3072 lds
    buffer_load_dwordx4 v[48:51], v20, s[16:19], s42 offen
    buffer_load_dwordx4 v[52:55], v20, s[16:19], s42 offen offset:512
    s_mov_b32 exec_lo, 0xffff
    s_mov_b32 exec_hi, 0xffff
    buffer_load_dwordx4 v[56:59], v20, s[16:19], s42 offen offset:1024
    s_mov_b64 exec, -1
    v_mov_b32 v23, 0
    buffer_load_dword v22, v23, s[28:31], 0 offen sc1
    s_add_u32 s57, s56, 3
    s_cmp_ge_u32 s57, 10
    s_cselect_b32 s15, 10, 0
    s_sub_u32 s57, s57, s15
    s_add_u32 m0, s40, 49152
    s_lshl_b32 s15, s57, 7
    s_add_u32 s15, s37, s15
    buffer_load_dwordx4 v12, s[16:19], s15 offen offset:0 lds
    buffer_load_dwordx4 v13, s[16:19], s15 offen offset:1024 lds
    buffer_load_dwordx4 v14, s[16:19], s15 offen offset:2048 lds
    buffer_load_dwordx4 v15, s[16:19], s15 offen offset:3072 lds
    s_add_u32 m0, s40, 131072
    s_mul_i32 s15, s57, 245760
    s_add_u32 s15, s38, s15
    buffer_load_dwordx4 v16, s[20:23], s15 offen offset:0 lds
    buffer_load_dwordx4 v17, s[20:23], s15 offen offset:1024 lds
    buffer_load_dwordx4 v18, s[20:23], s15 offen offset:2048 lds
    buffer_load_dwordx4 v19, s[20:23], s15 offen offset:3072 lds
    s_waitcnt vmcnt(20)
    s_barrier
    s_add_u32 s57, s56, 4
    s_cmp_ge_u32 s57, 10
    s_cselect_b32 s15, 10, 0
    s_sub_u32 s57, s57, s15
    s_add_u32 m0, s40, 65536
    s_lshl_b32 s15, s57, 7
    s_add_u32 s15, s37, s15
    buffer_load_dwordx4 v12, s[16:19], s15 offen offset:0 lds
    buffer_load_dwordx4 v13, s[16:19], s15 offen offset:1024 lds
    buffer_load_dwordx4 v14, s[16:19], s15 offen offset:2048 lds
    buffer_load_dwordx4 v15, s[16:19], s15 offen offset:3072 lds
    s_add_u32 m0, s40, 81920
    s_mul_i32 s15, s57, 245760
    s_add_u32 s15, s38, s15
    buffer_load_dwordx4 v16, s[20:23], s15 offen offset:0 lds
    buffer_load_dwordx4 v17, s[20:23], s15 offen offset:1024 lds
    buffer_load_dwordx4 v18, s[20:23], s15 offen offset:2048 lds
    buffer_load_dwordx4 v19, s[20:23], s15 offen offset:3072 lds
    s_waitcnt vmcnt(20)
    s_barrier
    s_add_u32 s57, s56, 5
    s_cmp_ge_u32 s57, 10
    s_cselect_b32 s15, 10, 0
    s_sub_u32 s57, s57, s15
    s_add_u32 m0, s40, 0
    s_lshl_b32 s15, s57, 7
    s_add_u32 s15, s37, s15
    buffer_load_dwordx4 v12, s[16:19], s15 offen offset:0 lds
    buffer_load_dwordx4 v13, s[16:19], s15 offen offset:1024 lds
    buffer_load_dwordx4 v14, s[16:19], s15 offen offset:2048 lds
    buffer_load_dwordx4 v15, s[16:19], s15 offen offset:3072 lds
    s_add_u32 m0, s40, 98304
    s_mul_i32 s15, s57, 245760
    s_add_u32 s15, s38, s15
    buffer_load_dwordx4 v16, s[20:23], s15 offen offset:0 lds
    buffer_load_dwordx4 v17, s[20:23], s15 offen offset:1024 lds
    buffer_load_dwordx4 v18, s[20:23], s15 offen offset:2048 lds
    buffer_load_dwordx4 v19, s[20:23], s15 offen offset:3072 lds
    s_waitcnt vmcnt(16)
    s_barrier
    s_add_u32 s57, s56, 6
    s_cmp_ge_u32 s57, 10
    s_cselect_b32 s15, 10, 0
    s_sub_u32 s57, s57, s15
    s_add_u32 m0, s40, 16384
    s_lshl_b32 s15, s57, 7
    s_add_u32 s15, s37, s15
    buffer_load_dwordx4 v12, s[16:19], s15 offen offset:0 lds
    buffer_load_dwordx4 v13, s[16:19], s15 offen offset:1024 lds
    buffer_load_dwordx4 v14, s[16:19], s15 offen offset:2048 lds
    buffer_load_dwordx4 v15, s[16:19], s15 offen offset:3072 lds
    s_add_u32 m0, s40, 114688
    s_mul_i32 s15, s57, 245760
    s_add_u32 s15, s38, s15
    buffer_load_dwordx4 v16, s[20:23], s15 offen offset:0 lds
    buffer_load_dwordx4 v17, s[20:23], s15 offen offset:1024 lds
    buffer_load_dwordx4 v18, s[20:23], s15 offen offset:2048 lds
    buffer_load_dwordx4 v19, s[20:23], s15 offen offset:3072 lds
    v_lshlrev_b32 v36, 16, v48
    v_and_b32 v37, 0xffff0000, v48
    v_add_f32 v32, v32, v36
    v_add_f32 v34, v34, v37
    v_fmac_f32 v33, v36, v36
    v_fmac_f32 v35, v37, v37
    v_lshlrev_b32 v36, 16, v49
    v_and_b32 v37, 0xffff0000, v49
    v_add_f32 v32, v32, v36
    v_add_f32 v34, v34, v37
    v_fmac_f32 v33, v36, v36
    v_fmac_f32 v35, v37, v37
    v_lshlrev_b32 v36, 16, v50
    v_and_b32 v37, 0xffff0000, v50
    v_add_f32 v32, v32, v36
    v_add_f32 v34, v34, v37
    v_fmac_f32 v33, v36, v36
    v_fmac_f32 v35, v37, v37
    v_lshlrev_b32 v36, 16, v51
    v_and_b32 v37, 0xffff0000, v51
    v_add_f32 v32, v32, v36
    v_add_f32 v34, v34, v37
    v_fmac_f32 v33, v36, v36
    v_fmac_f32 v35, v37, v37
    v_lshlrev_b32 v36, 16, v52
    v_and_b32 v37, 0xffff0000, v52
    v_add_f32 v32, v32, v36
    v_add_f32 v34, v34, v37
    v_fmac_f32 v33, v36, v36
    v_fmac_f32 v35, v37, v37
    v_lshlrev_b32 v36, 16, v53
    v_and_b32 v37, 0xffff0000, v53
    v_add_f32 v32, v32, v36
    v_add_f32 v34, v34, v37
    v_fmac_f32 v33, v36, v36
    v_fmac_f32 v35, v37, v37
    v_lshlrev_b32 v36, 16, v54
    v_and_b32 v37, 0xffff0000, v54
    v_add_f32 v32, v32, v36
    v_add_f32 v34, v34, v37
    v_fmac_f32 v33, v36, v36
    v_fmac_f32 v35, v37, v37
    v_lshlrev_b32 v36, 16, v55
    v_and_b32 v37, 0xffff0000, v55
    v_add_f32 v32, v32, v36
    v_add_f32 v34, v34, v37
    v_fmac_f32 v33, v36, v36
    v_fmac_f32 v35, v37, v37
    v_lshlrev_b32 v36, 16, v56
    v_and_b32 v37, 0xffff0000, v56
    v_add_f32 v32, v32, v36
    v_add_f32 v34, v34, v37
    v_fmac_f32 v33, v36, v36
    v_fmac_f32 v35, v37, v37
    v_lshlrev_b32 v36, 16, v57
    v_and_b32 v37, 0xffff0000, v57
    v_add_f32 v32, v32, v36
    v_add_f32 v34, v34, v37
    v_fmac_f32 v33, v36, v36
    v_fmac_f32 v35, v37, v37
    v_lshlrev_b32 v36, 16, v58
    v_and_b32 v37, 0xffff0000, v58
    v_add_f32 v32, v32, v36
    v_add_f32 v34, v34, v37
    v_fmac_f32 v33, v36, v36
    v_fmac_f32 v35, v37, v37
    v_lshlrev_b32 v36, 16, v59
    v_and_b32 v37, 0xffff0000, v59
    v_add_f32 v32, v32, v36
    v_add_f32 v34, v34, v37
    v_fmac_f32 v33, v36, v36
    v_fmac_f32 v35, v37, v37
    s_waitcnt vmcnt(16)
    s_barrier
    s_add_u32 s57, s56, 7
    s_cmp_ge_u32 s57, 10
    s_cselect_b32 s15, 10, 0
    s_sub_u32 s57, s57, s15
    s_add_u32 m0, s40, 32768
    s_lshl_b32 s15, s57, 7
    s_add_u32 s15, s37, s15
    buffer_load_dwordx4 v12, s[16:19], s15 offen offset:0 lds
    buffer_load_dwordx4 v13, s[16:19], s15 offen offset:1024 lds
    buffer_load_dwordx4 v14, s[16:19], s15 offen offset:2048 lds
    buffer_load_dwordx4 v15, s[16:19], s15 offen offset:3072 lds
    s_add_u32 m0, s40, 131072
    s_mul_i32 s15, s57, 245760
    s_add_u32 s15, s38, s15
    buffer_load_dwordx4 v16, s[20:23], s15 offen offset:0 lds
    buffer_load_dwordx4 v17, s[20:23], s15 offen offset:1024 lds
    buffer_load_dwordx4 v18, s[20:23], s15 offen offset:2048 lds
    buffer_load_dwordx4 v19, s[20:23], s15 offen offset:3072 lds
    v_add_f32 v32, v32, v34
    v_add_f32 v33, v33, v35
    s_nop 1
    v_add_f32_dpp v32, v32, v32 quad_perm:[1,0,3,2] row_mask:0xf bank_mask:0xf
    v_add_f32_dpp v33, v33, v33 quad_perm:[1,0,3,2] row_mask:0xf bank_mask:0xf
    s_nop 1
    v_add_f32_dpp v32, v32, v32 quad_perm:[2,3,0,1] row_mask:0xf bank_mask:0xf
    v_add_f32_dpp v33, v33, v33 quad_perm:[2,3,0,1] row_mask:0xf bank_mask:0xf
    s_nop 1
    v_add_f32_dpp v32, v32, v32 row_half_mirror row_mask:0xf bank_mask:0xf
    v_add_f32_dpp v33, v33, v33 row_half_mirror row_mask:0xf bank_mask:0xf
    s_nop 1
    v_add_f32_dpp v32, v32, v32 row_mirror row_mask:0xf bank_mask:0xf
    v_add_f32_dpp v33, v33, v33 row_mirror row_mask:0xf bank_mask:0xf
    v_mov_b32 v34, v32
    v_mov_b32 v35, v33
    s_nop 1
    v_permlane16_swap_b32 v32, v34
    v_permlane16_swap_b32 v33, v35
    v_add_f32 v32, v32, v34
    v_add_f32 v33, v33, v35
    s_mov_b32 s73, 0
P1L_nc_l:
    v_readfirstlane_b32 s3, v22
    s_add_u32 s73, s73, 1
    s_cmp_lg_u32 s3, 0
    s_cbranch_scc1 P1L_nc_ok
    s_cmp_lt_u32 s73, 200000
    s_cbranch_scc0 P1L_nc_ok
    v_mov_b32 v23, 0
    buffer_load_dword v22, v23, s[28:31], 0 offen sc1
    s_waitcnt vmcnt(0)
    s_branch P1L_nc_l
P1L_nc_ok:
    s_lshl_b32 s15, s41, 4
    s_add_u32 s15, s15, 18350080
    v_lshlrev_b32 v36, 4, v4
    v_mov_b32 v34, s3
    v_mov_b32 v35, s3
    s_mov_b32 exec_lo, 1
    s_mov_b32 exec_hi, 1
    buffer_store_dwordx4 v[32:35], v36, s[24:27], s15 offen sc1
    s_mov_b64 exec, -1
    s_waitcnt vmcnt(17)
    s_barrier
    s_add_u32 s57, s56, 8
    s_cmp_ge_u32 s57, 10
    s_cselect_b32 s15, 10, 0
    s_sub_u32 s57, s57, s15
    s_add_u32 m0, s40, 49152
    s_lshl_b32 s15, s57, 7
    s_add_u32 s15, s37, s15
    buffer_load_dwordx4 v12, s[16:19], s15 offen offset:0 lds
    buffer_load_dwordx4 v13, s[16:19], s15 offen offset:1024 lds
    buffer_load_dwordx4 v14, s[16:19], s15 offen offset:2048 lds
    buffer_load_dwordx4 v15, s[16:19], s15 offen offset:3072 lds
    s_add_u32 m0, s40, 81920
    s_mul_i32 s15, s57, 245760
    s_add_u32 s15, s38, s15
    buffer_load_dwordx4 v16, s[20:23], s15 offen offset:0 lds
    buffer_load_dwordx4 v17, s[20:23], s15 offen offset:1024 lds
    buffer_load_dwordx4 v18, s[20:23], s15 offen offset:2048 lds
    buffer_load_dwordx4 v19, s[20:23], s15 offen offset:3072 lds
    s_waitcnt vmcnt(17)
    s_barrier
    s_add_u32 s57, s56, 9
    s_cmp_ge_u32 s57, 10
    s_cselect_b32 s15, 10, 0
    s_sub_u32 s57, s57, s15
    s_add_u32 m0, s40, 65536
    s_lshl_b32 s15, s57, 7
    s_add_u32 s15, s37, s15
    buffer_load_dwordx4 v12, s[16:19], s15 offen offset:0 lds
    buffer_load_dwordx4 v13, s[16:19], s15 offen offset:1024 lds
    buffer_load_dwordx4 v14, s[16:19], s15 offen offset:2048 lds
    buffer_load_dwordx4 v15, s[16:19], s15 offen offset:3072 lds
    s_add_u32 m0, s40, 98304
    s_mul_i32 s15, s57, 245760
    s_add_u32 s15, s38, s15
    buffer_load_dwordx4 v16, s[20:23], s15 offen offset:0 lds
    buffer_load_dwordx4 v17, s[20:23], s15 offen offset:1024 lds
    buffer_load_dwordx4 v18, s[20:23], s15 offen offset:2048 lds
    buffer_load_dwordx4 v19, s[20:23], s15 offen offset:3072 lds
    s_waitcnt vmcnt(17)
    s_barrier
    s_mov_b32 s20, s98
    s_and_b32 s21, s99, 0xffff
    s_mov_b32 s22, 1966080
    s_mov_b32 s23, 0x00020000
    v_lshrrev_b32 v10, 3, v8
    v_lshlrev_b32 v9, 1, v10
    v_xor_b32 v9, v9, v8
    v_and_b32 v9, 7, v9
    v_lshlrev_b32 v9, 4, v9
    v_mul_u32_u24 v10, 1536, v10
    v_mul_u32_u24 v11, 3072, v6
    v_add3_u32 v9, v9, v10, v11
    v_add_u32 v16, 0, v9
    v_add_u32 v17, 11264, v9
    v_add_u32 v18, 22528, v9
    v_add_u32 v19, 33792, v9
    s_mul_i32 s38, s12, 49152
    s_mul_i32 s15, s36, 96
    s_and_b32 s15, s15, 0xffffffc0
    s_add_u32 s38, s38, s15
    s_add_u32 s57, s56, 9
    s_cmp_ge_u32 s57, 10
    s_cselect_b32 s15, 10, 0
    s_sub_u32 s57, s57, s15
    s_add_u32 m0, s40, 114688
    s_mul_i32 s15, s57, 196608
    s_add_u32 s15, s38, s15
    buffer_load_dwordx4 v16, s[20:23], s15 offen offset:0 lds
    buffer_load_dwordx4 v17, s[20:23], s15 offen offset:1024 lds
    buffer_load_dwordx4 v18, s[20:23], s15 offen offset:2048 lds
    buffer_load_dwordx4 v19, s[20:23], s15 offen offset:3072 lds
    s_waitcnt vmcnt(12)
    s_barrier
    s_add_u32 s57, s56, 8
    s_cmp_ge_u32 s57, 10
    s_cselect_b32 s15, 10, 0
    s_sub_u32 s57, s57, s15
    s_add_u32 m0, s40, 131072
    s_mul_i32 s15, s57, 196608
    s_add_u32 s15, s38, s15
    buffer_load_dwordx4 v16, s[20:23], s15 offen offset:0 lds
    buffer_load_dwordx4 v17, s[20:23], s15 offen offset:1024 lds
    buffer_load_dwordx4 v18, s[20:23], s15 offen offset:2048 lds
    buffer_load_dwordx4 v19, s[20:23], s15 offen offset:3072 lds
    s_waitcnt vmcnt(8)
    s_barrier
    s_add_u32 s57, s56, 7
    s_cmp_ge_u32 s57, 10
    s_cselect_b32 s15, 10, 0
    s_sub_u32 s57, s57, s15
    s_add_u32 m0, s40, 81920
    s_mul_i32 s15, s57, 196608
    s_add_u32 s15, s38, s15
    buffer_load_dwordx4 v16, s[20:23], s15 offen offset:0 lds
    buffer_load_dwordx4 v17, s[20:23], s15 offen offset:1024 lds
    buffer_load_dwordx4 v18, s[20:23], s15 offen offset:2048 lds
    buffer_load_dwordx4 v19, s[20:23], s15 offen offset:3072 lds
    s_waitcnt vmcnt(8)
    s_barrier
    s_add_u32 s57, s56, 6
    s_cmp_ge_u32 s57, 10
    s_cselect_b32 s15, 10, 0
    s_sub_u32 s57, s57, s15
    s_add_u32 m0, s40, 98304
    s_mul_i32 s15, s57, 196608
    s_add_u32 s15, s38, s15
    buffer_load_dwordx4 v16, s[20:23], s15 offen offset:0 lds
    buffer_load_dwordx4 v17, s[20:23], s15 offen offset:1024 lds
    buffer_load_dwordx4 v18, s[20:23], s15 offen offset:2048 lds
    buffer_load_dwordx4 v19, s[20:23], s15 offen offset:3072 lds
    s_waitcnt vmcnt(8)
    s_barrier
    s_add_u32 s57, s56, 5
    s_cmp_ge_u32 s57, 10
    s_cselect_b32 s15, 10, 0
    s_sub_u32 s57, s57, s15
    s_add_u32 m0, s40, 114688
    s_mul_i32 s15, s57, 196608
    s_add_u32 s15, s38, s15
    buffer_load_dwordx4 v16, s[20:23], s15 offen offset:0 lds
    buffer_load_dwordx4 v17, s[20:23], s15 offen offset:1024 lds
    buffer_load_dwordx4 v18, s[20:23], s15 offen offset:2048 lds
    buffer_load_dwordx4 v19, s[20:23], s15 offen offset:3072 lds
    s_waitcnt vmcnt(8)
    s_barrier
    s_add_u32 s57, s56, 4
    s_cmp_ge_u32 s57, 10
    s_cselect_b32 s15, 10, 0
    s_sub_u32 s57, s57, s15
    s_add_u32 m0, s40, 65536
    s_lshl_b32 s15, s57, 7
    s_add_u32 s15, s37, s15
    buffer_load_dwordx4 v12, s[16:19], s15 offen offset:0 lds
    buffer_load_dwordx4 v13, s[16:19], s15 offen offset:1024 lds
    buffer_load_dwordx4 v14, s[16:19], s15 offen offset:2048 lds
    buffer_load_dwordx4 v15, s[16:19], s15 offen offset:3072 lds
    s_add_u32 m0, s40, 131072
    s_mul_i32 s15, s57, 196608
    s_add_u32 s15, s38, s15
    buffer_load_dwordx4 v16, s[20:23], s15 offen offset:0 lds
    buffer_load_dwordx4 v17, s[20:23], s15 offen offset:1024 lds
    buffer_load_dwordx4 v18, s[20:23], s15 offen offset:2048 lds
    buffer_load_dwordx4 v19, s[20:23], s15 offen offset:3072 lds
    s_waitcnt vmcnt(12)
    s_barrier
    s_add_u32 s57, s56, 3
    s_cmp_ge_u32 s57, 10
    s_cselect_b32 s15, 10, 0
    s_sub_u32 s57, s57, s15
    s_add_u32 m0, s40, 49152
    s_lshl_b32 s15, s57, 7
    s_add_u32 s15, s37, s15
    buffer_load_dwordx4 v12, s[16:19], s15 offen offset:0 lds
    buffer_load_dwordx4 v13, s[16:19], s15 offen offset:1024 lds
    buffer_load_dwordx4 v14, s[16:19], s15 offen offset:2048 lds
    buffer_load_dwordx4 v15, s[16:19], s15 offen offset:3072 lds
    s_add_u32 m0, s40, 81920
    s_mul_i32 s15, s57, 196608
    s_add_u32 s15, s38, s15
    buffer_load_dwordx4 v16, s[20:23], s15 offen offset:0 lds
    buffer_load_dwordx4 v17, s[20:23], s15 offen offset:1024 lds
    buffer_load_dwordx4 v18, s[20:23], s15 offen offset:2048 lds
    buffer_load_dwordx4 v19, s[20:23], s15 offen offset:3072 lds
    s_waitcnt vmcnt(16)
    s_barrier
    s_add_u32 s57, s56, 2
    s_cmp_ge_u32 s57, 10
    s_cselect_b32 s15, 10, 0
    s_sub_u32 s57, s57, s15
    s_add_u32 m0, s40, 32768
    s_lshl_b32 s15, s57, 7
    s_add_u32 s15, s37, s15
    buffer_load_dwordx4 v12, s[16:19], s15 offen offset:0 lds
    buffer_load_dwordx4 v13, s[16:19], s15 offen offset:1024 lds
    buffer_load_dwordx4 v14, s[16:19], s15 offen offset:2048 lds
    buffer_load_dwordx4 v15, s[16:19], s15 offen offset:3072 lds
    s_add_u32 m0, s40, 98304
    s_mul_i32 s15, s57, 196608
    s_add_u32 s15, s38, s15
    buffer_load_dwordx4 v16, s[20:23], s15 offen offset:0 lds
    buffer_load_dwordx4 v17, s[20:23], s15 offen offset:1024 lds
    buffer_load_dwordx4 v18, s[20:23], s15 offen offset:2048 lds
    buffer_load_dwordx4 v19, s[20:23], s15 offen offset:3072 lds
    s_waitcnt vmcnt(16)
    s_barrier
    s_add_u32 s57, s56, 1
    s_cmp_ge_u32 s57, 10
    s_cselect_b32 s15, 10, 0
    s_sub_u32 s57, s57, s15
    s_add_u32 m0, s40, 16384
    s_lshl_b32 s15, s57, 7
    s_add_u32 s15, s37, s15
    buffer_load_dwordx4 v12, s[16:19], s15 offen offset:0 lds
    buffer_load_dwordx4 v13, s[16:19], s15 offen offset:1024 lds
    buffer_load_dwordx4 v14, s[16:19], s15 offen offset:2048 lds
    buffer_load_dwordx4 v15, s[16:19], s15 offen offset:3072 lds
    s_add_u32 m0, s40, 114688
    s_mul_i32 s15, s57, 196608
    s_add_u32 s15, s38, s15
    buffer_load_dwordx4 v16, s[20:23], s15 offen offset:0 lds
    buffer_load_dwordx4 v17, s[20:23], s15 offen offset:1024 lds
    buffer_load_dwordx4 v18, s[20:23], s15 offen offset:2048 lds
    buffer_load_dwordx4 v19, s[20:23], s15 offen offset:3072 lds
    s_waitcnt vmcnt(16)
    s_barrier
    s_add_u32 s57, s56, 0
    s_cmp_ge_u32 s57, 10
    s_cselect_b32 s15, 10, 0
    s_sub_u32 s57, s57, s15
    s_add_u32 m0, s40, 0
    s_lshl_b32 s15, s57, 7
    s_add_u32 s15, s37, s15
    buffer_load_dwordx4 v12, s[16:19], s15 offen offset:0 lds
    buffer_load_dwordx4 v13, s[16:19], s15 offen offset:1024 lds
    buffer_load_dwordx4 v14, s[16:19], s15 offen offset:2048 lds
    buffer_load_dwordx4 v15, s[16:19], s15 offen offset:3072 lds
    s_add_u32 m0, s40, 131072
    s_mul_i32 s15, s57, 196608
    s_add_u32 s15, s38, s15
    buffer_load_dwordx4 v16, s[20:23], s15 offen offset:0 lds
    buffer_load_dwordx4 v17, s[20:23], s15 offen offset:1024 lds
    buffer_load_dwordx4 v18, s[20:23], s15 offen offset:2048 lds
    buffer_load_dwordx4 v19, s[20:23], s15 offen offset:3072 lds
    s_waitcnt vmcnt(16)
    s_barrier
    s_waitcnt vmcnt(8)
    s_barrier
    s_waitcnt vmcnt(0)
    s_barrier
    s_lshl_b32 s56, s32, 1
    s_add_u32 s56, s56, s33
    s_sub_u32 s56, s56, 2
    s_and_b32 s15, s12, 1
    s_add_u32 s15, s15, 1
    s_mul_i32 s57, s15, 80
    v_cmp_gt_u32 vcc, 32, v2
    v_bfe_u32 v24, v2, 4, 1
    v_bfe_u32 v25, v2, 2, 1
    v_cndmask_b32 v24, v25, v24, vcc
    v_mov_b32 v25, s57
    v_cndmask_b32 v25, 0, v25, vcc
    v_lshl_add_u32 v24, v24, 1, v25
    v_add_u32 v24, s56, v24
    v_lshrrev_b32 v24, 3, v24
    s_lshr_b32 s15, s12, 1
    s_lshl_b32 s15, s15, 4
    v_and_b32 v25, 15, v2
    v_add_u32 v25, s15, v25
    s_lshl_b32 s15, s14, 2
    v_and_b32 v26, 3, v2
    v_add_u32 v26, s15, v26
    v_cndmask_b32 v25, v26, v25, vcc
    v_lshl_add_u32 v24, v24, 5, v25
    v_lshlrev_b32 v24, 2, v24
    s_mov_b32 s71, 27217920
    buffer_load_dword v25, v24, s[24:27], s71 offen sc1
    s_waitcnt vmcnt(1)
    s_barrier
    v_lshlrev_b32 v12, 4, v2
    s_and_b32 s15, s12, 1
    s_add_u32 s35, s15, 1
    s_mul_i32 s35, s35, 80
    s_lshr_b32 s36, s12, 1
    s_lshl_b32 s37, s36, 4
    s_add_u32 s38, s34, s35
    s_lshl_b32 s38, s38, 5
    s_add_u32 s38, s38, s37
    s_lshl_b32 s38, s38, 10
    s_add_u32 s39, s38, 31744
    s_add_u32 s40, s33, s35
    s_lshl_b32 s40, s40, 5
    s_add_u32 s40, s40, s37
    s_lshl_b32 s40, s40, 10
    s_sub_u32 s40, s40, 2048
    s_mul_i32 s41, s12, 3072
    s_mov_b32 s42, 0
    s_waitcnt vmcnt(0)
    s_mov_b32 s72, 0
    s_branch G_pq_c
G_pq_l:
    buffer_load_dword v25, v24, s[24:27], s71 offen offset:0 sc1
    s_add_u32 s72, s72, 1
    s_waitcnt vmcnt(0)
G_pq_c:
    v_cmp_ne_u32 vcc, s3, v25
    s_and_b64 vcc, vcc, exec
    s_cbranch_scc0 G_pq_ok
    s_cmp_lt_u32 s72, 200000
    s_cbranch_scc0 G_pq_ok
    s_sleep 6
    s_branch G_pq_l
G_pq_ok:
    s_mov_b32 m0, s41
    s_add_u32 s42, s42, 1
    buffer_load_dwordx4 v12, s[24:27], s38 offen sc1 lds
    buffer_load_dwordx4 v12, s[24:27], s39 offen offset:1024 sc1 lds
    s_add_u32 s38, s38, 1024
    s_add_u32 s39, s39, 1024
    buffer_load_dwordx4 v12, s[24:27], s40 offen offset:2048 sc1 lds
    s_add_u32 s40, s40, 1024
    s_cmp_eq_u32 s42, 3
    s_movk_i32 s15, 13312
    s_cmovk_i32 s15, 38912
    s_cmov_b32 s42, 0
    s_add_u32 s41, s41, s15
    s_mov_b32 m0, s41
    s_add_u32 s42, s42, 1
    buffer_load_dwordx4 v12, s[24:27], s38 offen sc1 lds
    buffer_load_dwordx4 v12, s[24:27], s39 offen offset:1024 sc1 lds
    s_add_u32 s38, s38, 1024
    s_add_u32 s39, s39, 1024
    buffer_load_dwordx4 v12, s[24:27], s40 offen offset:2048 sc1 lds
    s_add_u32 s40, s40, 1024
    s_cmp_eq_u32 s42, 3
    s_movk_i32 s15, 13312
    s_cmovk_i32 s15, 38912
    s_cmov_b32 s42, 0
    s_add_u32 s41, s41, s15
    v_mov_b32 v28, 0x3f803f80
    v_mov_b32 v29, 0
    v_mov_b32 v30, 0
    v_mov_b32 v31, 0
    s_min_u32 s15, s12, 2
    s_mul_i32 s15, s15, 13312
    s_add_u32 s15, s15, 12288
    v_add_u32 v8, s15, v12
    ds_write_b128 v8, v[28:31]
    s_lshl_b32 s15, s12, 2
    s_add_u32 s15, s15, 162816
    v_mov_b32 v8, s15
    ds_write_b32 v8, v29
    ds_write_b32 v8, v29 offset:16
    s_waitcnt lgkmcnt(0)
    v_lshrrev_b32 v5, 4, v2
    v_and_b32 v6, 15, v2
    s_mul_i32 s66, s12, 6144
    s_add_u32 s66, s66, 138240
    s_mul_i32 s15, s64, 48
    s_mul_i32 s67, s65, 3
    s_add_u32 s15, s15, s67
    s_lshl_b32 s67, s15, 10
    s_mul_i32 s15, s12, 6144
    s_add_u32 s15, s15, 81920
    v_add_u32 v7, s15, v12
    s_lshl_b32 s15, s12, 8
    s_add_u32 s15, s15, 147456
    v_lshl_add_u32 v8, v3, 3, s15
    v_mov_b32 v30, s3
    v_mov_b32 v31, s3
    s_lshl_b32 s15, s64, 4
    s_add_u32 s15, s15, s65
    s_lshl_b32 s15, s15, 9
    s_add_u32 s69, s15, 17825792
    s_barrier
    ds_read_b64 v[28:29], v8
    ds_read_b128 v[36:39], v7 offset:3072
    ds_read_b128 v[40:43], v7 offset:4096
    ds_read_b128 v[44:47], v7 offset:5120
    s_waitcnt lgkmcnt(3)
    s_mov_b32 exec_hi, 0
    buffer_store_dwordx4 v[28:31], v12, s[24:27], s69 offen sc1
    s_mov_b32 exec_hi, -1
    v_lshlrev_b32 v9, 4, v3
    v_lshl_add_u32 v9, v4, 12, v9
    s_mov_b32 s16, s44
    s_and_b32 s17, s45, 0xffff
    s_mov_b32 s18, 8388608
    s_mov_b32 s19, 0x00020000
    s_mov_b32 s20, s46
    s_and_b32 s21, s47, 0xffff
    s_mov_b32 s22, 4096
    s_mov_b32 s23, 0x00020000
    s_mov_b32 s28, s10
    s_and_b32 s29, s11, 0xffff
    s_mov_b32 s30, 17825792
    s_mov_b32 s31, 0x00020000
    s_and_b32 s48, s2, 3
    s_lshl_b32 s48, s48, 3
    s_add_u32 s48, s48, s14
    s_bfe_u32 s49, s2, 0x10002
    s_lshl_b32 s49, s49, 2
    s_lshr_b32 s15, s2, 6
    s_add_u32 s49, s49, s15
    s_and_b32 s56, s12, 1
    s_lshr_b32 s57, s12, 1
    s_lshl_b32 s70, s49, 1
    s_add_u32 s70, s70, s57
    s_mul_i32 s50, s56, 48
    s_mul_i32 s15, s70, 3
    s_add_u32 s50, s50, s15
    s_lshl_b32 s50, s50, 10
    s_add_u32 s50, s50, 14680064
    s_lshl_b32 s15, s57, 10
    v_add_u32 v34, s15, v12
    s_lshl_b32 s15, s57, 11
    s_sub_u32 s15, 2048, s15
    v_add_u32 v35, s15, v12
    s_lshl_b32 s51, s48, 18
    s_lshl_b32 s15, s12, 16
    s_add_u32 s51, s51, s15
    v_lshrrev_b32 v10, 3, v2
    v_and_b32 v11, 7, v2
    v_add_u32 v14, 0, v5
    v_xor_b32 v14, v14, v11
    v_lshlrev_b32 v14, 4, v14
    v_lshl_add_u32 v14, v10, 12, v14
    v_add_u32 v15, 4, v5
    v_xor_b32 v15, v15, v11
    v_lshlrev_b32 v15, 4, v15
    v_lshl_add_u32 v15, v10, 12, v15
    v_add_u32 v15, 31744, v15
    s_lshl_b32 s52, s12, 11
    s_add_u32 s52, s52, 39936
    s_mov_b32 s54, 0
    s_mov_b32 s77, 32768
    s_mov_b32 s78, 4294901760
    v_lshrrev_b32 v10, 1, v6
    s_lshl_b32 s15, s56, 2
    v_or_b32 v11, s15, v5
    v_xor_b32 v10, v10, v11
    v_lshlrev_b32 v10, 4, v10
    v_lshl_add_u32 v10, v6, 7, v10
    s_lshl_b32 s15, s56, 12
    v_add_u32 v10, s15, v10
    v_xor_b32 v11, 0x1000, v10
    v_add_u32 v16, 39936, v10
    v_add_u32 v17, 39936, v11
    v_mov_b32 v148, 0
    v_mov_b32 v149, 0
    v_mov_b32 v150, 0
    v_mov_b32 v151, 0
    v_mov_b32 v152, 0
    v_mov_b32 v153, 0
    v_mov_b32 v154, 0
    v_mov_b32 v155, 0
    v_mov_b32 v156, 0
    v_mov_b32 v157, 0
    v_mov_b32 v158, 0
    v_mov_b32 v159, 0
    v_mov_b32 v160, 0
    v_mov_b32 v161, 0
    v_mov_b32 v162, 0
    v_mov_b32 v163, 0
    v_mov_b32 v164, 0
    v_mov_b32 v165, 0
    v_mov_b32 v166, 0
    v_mov_b32 v167, 0
    v_mov_b32 v168, 0
    v_mov_b32 v169, 0
    v_mov_b32 v170, 0
    v_mov_b32 v171, 0
    v_mov_b32 v172, 0
    v_mov_b32 v173, 0
    v_mov_b32 v174, 0
    v_mov_b32 v175, 0
    v_mov_b32 v176, 0
    v_mov_b32 v177, 0
    v_mov_b32 v178, 0
    v_mov_b32 v179, 0
    v_mov_b32 v180, 0
    v_mov_b32 v181, 0
    v_mov_b32 v182, 0
    v_mov_b32 v183, 0
    v_mov_b32 v184, 0
    v_mov_b32 v185, 0
    v_mov_b32 v186, 0
    v_mov_b32 v187, 0
    v_mov_b32 v188, 0
    v_mov_b32 v189, 0
    v_mov_b32 v190, 0
    v_mov_b32 v191, 0
    v_mov_b32 v192, 0
    v_mov_b32 v193, 0
    v_mov_b32 v194, 0
    v_mov_b32 v195, 0
    s_mov_b32 s76, 0
    s_lshl_b32 s68, s64, 13
    s_add_u32 s68, s68, 17825792
    s_add_u32 s71, s67, 8388608
    s_waitcnt vmcnt(4)
    s_barrier
    ds_read_b128 v[100:103], v7 offset:0
    ds_read_b128 v[104:107], v7 offset:1024
    ds_read_b128 v[108:111], v7 offset:2048
    s_mov_b32 m0, s41
    s_add_u32 s42, s42, 1
    buffer_load_dwordx4 v12, s[24:27], s38 offen sc1 lds
    buffer_load_dwordx4 v12, s[24:27], s39 offen offset:1024 sc1 lds
    s_add_u32 s38, s38, 1024
    s_add_u32 s39, s39, 1024
    buffer_load_dwordx4 v12, s[24:27], s40 offen offset:2048 sc1 lds
    s_add_u32 s40, s40, 1024
    s_cmp_eq_u32 s42, 3
    s_movk_i32 s15, 13312
    s_cmovk_i32 s15, 38912
    s_cmov_b32 s42, 0
    s_add_u32 s41, s41, s15
    buffer_load_dwordx4 v[52:55], v9, s[24:27], s68 offen offset:0 sc1
    buffer_load_dwordx4 v[56:59], v9, s[24:27], s68 offen offset:512 sc1
    buffer_load_dwordx4 v[60:63], v9, s[24:27], s68 offen offset:1024 sc1
    buffer_load_dwordx4 v[64:67], v9, s[24:27], s68 offen offset:1536 sc1
    buffer_load_dwordx4 v[68:71], v9, s[24:27], s68 offen offset:2048 sc1
    buffer_load_dwordx4 v[72:75], v9, s[24:27], s68 offen offset:2560 sc1
    buffer_load_dwordx4 v[76:79], v9, s[24:27], s68 offen offset:3072 sc1
    buffer_load_dwordx4 v[80:83], v9, s[24:27], s68 offen offset:3584 sc1
    s_waitcnt lgkmcnt(0)
    buffer_store_dwordx4 v[100:103], v12, s[24:27], s71 offen offset:0 sc1
    buffer_store_dwordx4 v[104:107], v12, s[24:27], s71 offen offset:1024 sc1
    buffer_store_dwordx4 v[108:111], v12, s[24:27], s71 offen offset:2048 sc1
    s_lshl_b32 s80, s2, 2
    s_add_u32 s80, s80, s12
    s_cmp_lt_u32 s80, 880
    s_mov_b32 s55, 1073741824
    s_cmov_b32 s55, 0
    s_min_u32 s80, s80, 879
    s_mul_hi_u32 s81, s80, 0xCCCCCCD
    s_mul_i32 s15, s81, 20
    s_sub_u32 s82, s80, s15
    s_mul_i32 s83, s81, 40
    s_mov_b32 s6, 24
    s_mov_b32 s7, 4
    s_mov_b32 s61, 8
    s_mul_i32 s15, s81, 160
    s_sub_u32 s15, s15, 2544
    s_cmp_ge_u32 s81, 16
    s_cmov_b32 s83, s15
    s_cmovk_i32 s6, 80
    s_cmov_b32 s7, 40
    s_cmov_b32 s61, 4
    s_lshl_b32 s15, s81, 5
    s_sub_u32 s15, s15, 640
    s_cmp_ge_u32 s81, 20
    s_cmov_b32 s83, s15
    s_cmov_b32 s6, 8
    s_cmov_b32 s7, 4
    s_cmov_b32 s61, 16
    s_cselect_b32 s44, s8, s4
    s_cselect_b32 s45, s9, s5
    s_mov_b32 s46, 819200
    s_cmov_b32 s46, 983040
    s_and_b32 s45, s45, 0xffff
    s_mov_b32 s47, 0x00020000
    v_bfe_u32 v198, v2, 2, 2
    v_bfe_u32 v200, v2, 4, 1
    v_mul_lo_u32 v200, v200, s61
    v_add_u32 v199, v198, v200
    v_mul_lo_u32 v200, v4, s7
    v_add3_u32 v199, v199, v200, s83
    s_movk_i32 s15, 1280
    v_mul_lo_u32 v199, v199, s15
    v_and_b32 v200, 3, v2
    v_lshl_add_u32 v199, v200, 4, v199
    s_lshl_b32 s71, s82, 6
    s_mul_i32 s15, s6, 1280
    s_add_u32 s72, s71, s15
    s_sub_u32 s72, s72, 1024
    s_add_u32 s73, s66, 4096
    s_mov_b32 m0, s73
    s_nop 0
    buffer_load_dwordx4 v199, s[44:47], s71 offen lds
    buffer_load_dwordx4 v199, s[44:47], s72 offen offset:1024 lds
    s_waitcnt vmcnt(5)
    s_barrier
    s_mov_b32 m0, s41
    s_add_u32 s42, s42, 1
    buffer_load_dwordx4 v12, s[24:27], s38 offen sc1 lds
    buffer_load_dwordx4 v12, s[24:27], s39 offen offset:1024 sc1 lds
    s_add_u32 s38, s38, 1024
    s_add_u32 s39, s39, 1024
    buffer_load_dwordx4 v12, s[24:27], s40 offen offset:2048 sc1 lds
    s_add_u32 s40, s40, 1024
    s_cmp_eq_u32 s42, 3
    s_movk_i32 s15, 13312
    s_cmovk_i32 s15, 38912
    s_cmov_b32 s42, 0
    s_add_u32 s41, s41, s15
    s_mov_b32 s72, 0
G_sl:
    v_xor_b32 v54, s3, v54
    v_xor_b32 v58, s3, v58
    v_xor_b32 v62, s3, v62
    v_xor_b32 v66, s3, v66
    v_xor_b32 v70, s3, v70
    v_xor_b32 v74, s3, v74
    v_xor_b32 v78, s3, v78
    v_xor_b32 v82, s3, v82
    v_or3_b32 v10, v54, v58, v62
    v_or3_b32 v10, v10, v66, v70
    v_or3_b32 v10, v10, v74, v78
    v_or_b32 v10, v10, v82
    v_cmp_ne_u32 vcc, 0, v10
    s_add_u32 s72, s72, 1
    s_cbranch_vccz G_sok
    s_cmp_lt_u32 s72, 200000
    s_cbranch_scc0 G_sok
    s_sleep 4
    buffer_load_dwordx4 v[52:55], v9, s[24:27], s68 offen offset:0 sc1
    buffer_load_dwordx4 v[56:59], v9, s[24:27], s68 offen offset:512 sc1
    buffer_load_dwordx4 v[60:63], v9, s[24:27], s68 offen offset:1024 sc1
    buffer_load_dwordx4 v[64:67], v9, s[24:27], s68 offen offset:1536 sc1
    buffer_load_dwordx4 v[68:71], v9, s[24:27], s68 offen offset:2048 sc1
    buffer_load_dwordx4 v[72:75], v9, s[24:27], s68 offen offset:2560 sc1
    buffer_load_dwordx4 v[76:79], v9, s[24:27], s68 offen offset:3072 sc1
    buffer_load_dwordx4 v[80:83], v9, s[24:27], s68 offen offset:3584 sc1
    s_waitcnt vmcnt(0)
    s_branch G_sl
G_sok:
    v_add_f32 v52, v52, v56
    v_add_f32 v53, v53, v57
    v_add_f32 v52, v52, v60
    v_add_f32 v53, v53, v61
    v_add_f32 v52, v52, v64
    v_add_f32 v53, v53, v65
    v_add_f32 v52, v52, v68
    v_add_f32 v53, v53, v69
    v_add_f32 v52, v52, v72
    v_add_f32 v53, v53, v73
    v_add_f32 v52, v52, v76
    v_add_f32 v53, v53, v77
    v_add_f32 v52, v52, v80
    v_add_f32 v53, v53, v81
    v_mov_b32 v54, v52
    v_mov_b32 v55, v53
    s_nop 1
    v_permlane32_swap_b32 v52, v54
    v_permlane32_swap_b32 v53, v55
    v_add_f32 v52, v52, v54
    v_add_f32 v53, v53, v55
    v_mul_f32 v52, 0x3aaaaaab, v52
    v_mul_f32 v53, 0x3aaaaaab, v53
    v_fma_f32 v53, -v52, v52, v53
    v_max_f32 v53, 0, v53
    v_cvt_pk_bf16_f32 v53, v53, v53
    v_and_b32 v53, 0xffff0000, v53
    v_add_f32 v53, 0x3727c5ac, v53
    v_cvt_pk_bf16_f32 v53, v53, v53
    v_and_b32 v53, 0xffff0000, v53
    v_sqrt_f32 v53, v53
    v_cvt_pk_bf16_f32 v52, -v52, -v52
    v_cvt_pk_bf16_f32 v53, v53, v53
    v_and_b32 v53, 0xffff0000, v53
    v_rcp_f32 v55, v53
    v_and_b32 v54, 0xffff0000, v52
    v_mul_f32 v54, v54, v55
    v_lshlrev_b32 v56, 16, v36
    v_and_b32 v57, 0xffff0000, v36
    v_fma_f32 v56, v56, v55, v54
    v_fma_f32 v57, v57, v55, v54
    v_cvt_pk_bf16_f32 v36, v56, v57
    v_lshlrev_b32 v56, 16, v37
    v_and_b32 v57, 0xffff0000, v37
    v_fma_f32 v56, v56, v55, v54
    v_fma_f32 v57, v57, v55, v54
    v_cvt_pk_bf16_f32 v37, v56, v57
    v_lshlrev_b32 v56, 16, v38
    v_and_b32 v57, 0xffff0000, v38
    v_fma_f32 v56, v56, v55, v54
    v_fma_f32 v57, v57, v55, v54
    v_cvt_pk_bf16_f32 v38, v56, v57
    v_lshlrev_b32 v56, 16, v39
    v_and_b32 v57, 0xffff0000, v39
    v_fma_f32 v56, v56, v55, v54
    v_fma_f32 v57, v57, v55, v54
    v_cvt_pk_bf16_f32 v39, v56, v57
    v_lshlrev_b32 v56, 16, v40
    v_and_b32 v57, 0xffff0000, v40
    v_fma_f32 v56, v56, v55, v54
    v_fma_f32 v57, v57, v55, v54
    v_cvt_pk_bf16_f32 v40, v56, v57
    v_lshlrev_b32 v56, 16, v41
    v_and_b32 v57, 0xffff0000, v41
    v_fma_f32 v56, v56, v55, v54
    v_fma_f32 v57, v57, v55, v54
    v_cvt_pk_bf16_f32 v41, v56, v57
    v_lshlrev_b32 v56, 16, v42
    v_and_b32 v57, 0xffff0000, v42
    v_fma_f32 v56, v56, v55, v54
    v_fma_f32 v57, v57, v55, v54
    v_cvt_pk_bf16_f32 v42, v56, v57
    v_lshlrev_b32 v56, 16, v43
    v_and_b32 v57, 0xffff0000, v43
    v_fma_f32 v56, v56, v55, v54
    v_fma_f32 v57, v57, v55, v54
    v_cvt_pk_bf16_f32 v43, v56, v57
    v_lshlrev_b32 v56, 16, v44
    v_and_b32 v57, 0xffff0000, v44
    v_fma_f32 v56, v56, v55, v54
    v_fma_f32 v57, v57, v55, v54
    v_cvt_pk_bf16_f32 v44, v56, v57
    v_lshlrev_b32 v56, 16, v45
    v_and_b32 v57, 0xffff0000, v45
    v_fma_f32 v56, v56, v55, v54
    v_fma_f32 v57, v57, v55, v54
    v_cvt_pk_bf16_f32 v45, v56, v57
    v_lshlrev_b32 v56, 16, v46
    v_and_b32 v57, 0xffff0000, v46
    v_fma_f32 v56, v56, v55, v54
    v_fma_f32 v57, v57, v55, v54
    v_cvt_pk_bf16_f32 v46, v56, v57
    v_lshlrev_b32 v56, 16, v47
    v_and_b32 v57, 0xffff0000, v47
    v_fma_f32 v56, v56, v55, v54
    v_fma_f32 v57, v57, v55, v54
    v_cvt_pk_bf16_f32 v47, v56, v57
    v_add_u32 v10, s66, v12
    ds_write_b128 v10, v[36:39] offset:0
    ds_write_b128 v10, v[40:43] offset:1024
    ds_write_b128 v10, v[44:47] offset:2048
    v_bfe_u32 v11, v2, 2, 2
    v_lshl_add_u32 v11, v5, 3, v11
    v_lshlrev_b32 v11, 4, v11
    v_and_b32 v10, 1, v2
    v_lshl_add_u32 v11, v10, 9, v11
    v_bfe_u32 v10, v2, 1, 1
    v_lshl_add_u32 v11, v10, 3, v11
    v_add_u32 v11, s66, v11
    s_add_u32 s68, s67, 14680064
    s_waitcnt lgkmcnt(0)
    ds_read_b64_tr_b16 v[36:37], v11 offset:0
    ds_read_b64_tr_b16 v[38:39], v11 offset:64
    ds_read_b64_tr_b16 v[40:41], v11 offset:1024
    ds_read_b64_tr_b16 v[42:43], v11 offset:1088
    ds_read_b64_tr_b16 v[44:45], v11 offset:2048
    ds_read_b64_tr_b16 v[46:47], v11 offset:2112
    s_waitcnt lgkmcnt(0)
    buffer_store_dwordx4 v[36:39], v12, s[24:27], s68 offen offset:0 sc1
    buffer_store_dwordx4 v[40:43], v12, s[24:27], s68 offen offset:1024 sc1
    buffer_store_dwordx4 v[44:47], v12, s[24:27], s68 offen offset:2048 sc1
    s_waitcnt vmcnt(6)
    v_bfe_u32 v11, v2, 2, 2
    v_lshl_add_u32 v10, v5, 3, v11
    v_lshlrev_b32 v10, 6, v10
    v_and_b32 v203, 3, v2
    v_lshl_add_u32 v10, v203, 3, v10
    v_add_u32 v10, s73, v10
    ds_read_b64_tr_b16 v[196:197], v10 offset:0
    ds_read_b64_tr_b16 v[198:199], v10 offset:256
    ds_read_b64_tr_b16 v[200:201], v10 offset:32
    ds_read_b64_tr_b16 v[202:203], v10 offset:288
    s_lshl_b32 s15, s82, 1
    s_mul_i32 s15, s15, 44
    s_add_u32 s15, s15, s81
    s_lshl_b32 s15, s15, 10
    s_add_u32 s15, s15, s55
    s_add_u32 s71, s15, 25165824
    s_add_u32 s72, s71, 45056
    s_waitcnt lgkmcnt(0)
    buffer_store_dwordx4 v[196:199], v12, s[24:27], s71 offen sc1
    buffer_store_dwordx4 v[200:203], v12, s[24:27], s72 offen sc1
    s_barrier
    s_mov_b32 m0, s41
    s_add_u32 s42, s42, 1
    buffer_load_dwordx4 v12, s[24:27], s38 offen sc1 lds
    buffer_load_dwordx4 v12, s[24:27], s39 offen offset:1024 sc1 lds
    s_add_u32 s38, s38, 1024
    s_add_u32 s39, s39, 1024
    buffer_load_dwordx4 v12, s[24:27], s40 offen offset:2048 sc1 lds
    s_add_u32 s40, s40, 1024
    s_cmp_eq_u32 s42, 3
    s_movk_i32 s15, 13312
    s_cmovk_i32 s15, 38912
    s_cmov_b32 s42, 0
    s_add_u32 s41, s41, s15
    s_lshl_b32 s15, s65, 6
    s_add_u32 s15, s15, s64
    s_lshl_b32 s15, s15, 2
    s_add_u32 s71, s15, 27197440
    s_waitcnt vmcnt(3)
    v_mov_b32 v10, s3
    v_mov_b32 v11, 0
    s_mov_b64 exec, 1
    buffer_store_dword v10, v11, s[24:27], s71 offen sc1
    s_mov_b64 exec, -1
    s_lshl_b32 s15, s82, 6
    s_add_u32 s15, s15, s81
    s_lshl_b32 s15, s15, 2
    s_add_u32 s15, s15, s55
    s_add_u32 s71, s15, 27209728
    v_mov_b32 v10, s3
    v_mov_b32 v11, 0
    s_mov_b64 exec, 1
    buffer_store_dword v10, v11, s[24:27], s71 offen sc1
    s_mov_b64 exec, -1
    s_add_u32 m0, s52, 0
    s_add_u32 s54, s54, 1
    buffer_load_dwordx4 v14, s[16:19], s51 offen lds
    buffer_load_dwordx4 v15, s[16:19], s51 offen offset:1024 lds
    s_add_u32 m0, s52, 8192
    s_add_u32 s51, s51, 128
    buffer_load_dwordx4 v14, s[16:19], s51 offen lds
    buffer_load_dwordx4 v15, s[16:19], s51 offen offset:1024 lds
    s_add_u32 m0, s52, 16384
    s_add_u32 s51, s51, 128
    buffer_load_dwordx4 v14, s[16:19], s51 offen lds
    buffer_load_dwordx4 v15, s[16:19], s51 offen offset:1024 lds
    s_add_u32 m0, s52, 24576
    s_add_u32 s51, s51, 128
    buffer_load_dwordx4 v14, s[16:19], s51 offen lds
    buffer_load_dwordx4 v15, s[16:19], s51 offen offset:1024 lds
    s_add_u32 s51, s51, 128
    s_cmp_eq_u32 s54, 3
    s_cselect_b32 s15, s78, s77
    s_cmov_b32 s54, 0
    s_add_u32 s52, s52, s15
    s_barrier
    s_mov_b32 m0, s41
    s_add_u32 s42, s42, 1
    buffer_load_dwordx4 v12, s[24:27], s38 offen sc1 lds
    buffer_load_dwordx4 v12, s[24:27], s39 offen offset:1024 sc1 lds
    s_add_u32 s38, s38, 1024
    s_add_u32 s39, s39, 1024
    buffer_load_dwordx4 v12, s[24:27], s40 offen offset:2048 sc1 lds
    s_add_u32 s40, s40, 1024
    s_cmp_eq_u32 s42, 3
    s_movk_i32 s15, 13312
    s_cmovk_i32 s15, 38912
    s_cmov_b32 s42, 0
    s_add_u32 s41, s41, s15
    s_add_u32 m0, s52, 0
    s_add_u32 s54, s54, 1
    buffer_load_dwordx4 v14, s[16:19], s51 offen lds
    buffer_load_dwordx4 v15, s[16:19], s51 offen offset:1024 lds
    s_add_u32 m0, s52, 8192
    s_add_u32 s51, s51, 128
    buffer_load_dwordx4 v14, s[16:19], s51 offen lds
    buffer_load_dwordx4 v15, s[16:19], s51 offen offset:1024 lds
    s_add_u32 m0, s52, 16384
    s_add_u32 s51, s51, 128
    buffer_load_dwordx4 v14, s[16:19], s51 offen lds
    buffer_load_dwordx4 v15, s[16:19], s51 offen offset:1024 lds
    s_add_u32 m0, s52, 24576
    s_add_u32 s51, s51, 128
    buffer_load_dwordx4 v14, s[16:19], s51 offen lds
    buffer_load_dwordx4 v15, s[16:19], s51 offen offset:1024 lds
    s_add_u32 s51, s51, 128
    s_cmp_eq_u32 s54, 3
    s_cselect_b32 s15, s78, s77
    s_cmov_b32 s54, 0
    s_add_u32 s52, s52, s15
    s_waitcnt vmcnt(11)
    s_barrier
    s_mov_b32 m0, s41
    s_add_u32 s42, s42, 1
    buffer_load_dwordx4 v12, s[24:27], s38 offen sc1 lds
    buffer_load_dwordx4 v12, s[24:27], s39 offen offset:1024 sc1 lds
    s_add_u32 s38, s38, 1024
    s_add_u32 s39, s39, 1024
    buffer_load_dwordx4 v12, s[24:27], s40 offen offset:2048 sc1 lds
    s_add_u32 s40, s40, 1024
    s_cmp_eq_u32 s42, 3
    s_movk_i32 s15, 13312
    s_cmovk_i32 s15, 38912
    s_cmov_b32 s42, 0
    s_add_u32 s41, s41, s15
    s_lshl_b32 s15, s70, 8
    s_add_u32 s71, s15, 27197440
    v_lshlrev_b32 v9, 2, v2
    s_mov_b32 s72, 0
G_pz_l:
    buffer_load_dword v10, v9, s[24:27], s71 offen offset:0 sc1
    s_add_u32 s72, s72, 1
    s_waitcnt vmcnt(0)
G_pz_c:
    v_cmp_ne_u32 vcc, s3, v10
    s_and_b64 vcc, vcc, exec
    s_cbranch_scc0 G_pz_ok
    s_cmp_lt_u32 s72, 200000
    s_cbranch_scc0 G_pz_ok
    s_sleep 6
    s_branch G_pz_l
G_pz_ok:
    s_or_b32 s15, s2, s12
    s_cmp_eq_u32 s15, 0
    s_cbranch_scc0 G_nz
    s_mov_b32 s4, s100
    s_and_b32 s5, s101, 0xffff
    s_mov_b32 s6, 256
    s_mov_b32 s7, 0x00020000
    v_mov_b32 v10, 0
    s_mov_b64 exec, 1
    buffer_store_dword v10, v10, s[4:7], 0 offen sc1
    s_mov_b64 exec, -1
G_nz:
    buffer_load_dwordx4 v[100:103], v34, s[28:31], s50 offen offset:0 sc1
    buffer_load_dwordx4 v[104:107], v34, s[28:31], s50 offen offset:1024 sc1
    buffer_load_dwordx4 v[108:111], v35, s[28:31], s50 offen offset:0 sc1
    s_add_u32 s50, s50, 98304
    buffer_load_dwordx4 v[112:115], v34, s[28:31], s50 offen offset:0 sc1
    buffer_load_dwordx4 v[116:119], v34, s[28:31], s50 offen offset:1024 sc1
    buffer_load_dwordx4 v[120:123], v35, s[28:31], s50 offen offset:0 sc1
    s_add_u32 s50, s50, 98304
    buffer_load_dwordx4 v[124:127], v34, s[28:31], s50 offen offset:0 sc1
    buffer_load_dwordx4 v[128:131], v34, s[28:31], s50 offen offset:1024 sc1
    buffer_load_dwordx4 v[132:135], v35, s[28:31], s50 offen offset:0 sc1
    s_add_u32 s50, s50, 98304
    buffer_load_dwordx4 v[136:139], v34, s[28:31], s50 offen offset:0 sc1
    buffer_load_dwordx4 v[140:143], v34, s[28:31], s50 offen offset:1024 sc1
    buffer_load_dwordx4 v[144:147], v35, s[28:31], s50 offen offset:0 sc1
    s_add_u32 s50, s50, 98304
    s_mov_b32 s53, 4
    s_mov_b32 s73, 0
    s_lshl_b32 s60, s48, 1
    s_add_u32 s60, s60, s56
    s_setprio 0
    s_barrier
    s_waitcnt vmcnt(0)
    s_branch K2G_st0
K2G_stage:
    s_barrier
K2G_st0:
    ds_read_b128 v[36:39], v16 offset:0
    ds_read_b128 v[40:43], v16 offset:2048
    ds_read_b128 v[44:47], v17 offset:0
    ds_read_b128 v[48:51], v17 offset:2048
    ds_read_b128 v[52:55], v16 offset:8192
    ds_read_b128 v[56:59], v16 offset:10240
    ds_read_b128 v[60:63], v17 offset:8192
    ds_read_b128 v[64:67], v17 offset:10240
    ds_read_b128 v[68:71], v16 offset:16384
    ds_read_b128 v[72:75], v16 offset:18432
    ds_read_b128 v[76:79], v17 offset:16384
    ds_read_b128 v[80:83], v17 offset:18432
    s_waitcnt vmcnt(16) lgkmcnt(8)
    v_mfma_f32_16x16x32_bf16 v[148:151], v[100:103], v[36:39], v[148:151]
    ds_read_b128 v[84:87], v16 offset:24576
    v_mfma_f32_16x16x32_bf16 v[152:155], v[104:107], v[36:39], v[152:155]
    s_mov_b32 m0, s41
    s_add_u32 s42, s42, 1
    buffer_load_dwordx4 v12, s[24:27], s38 offen sc1 lds
    v_mfma_f32_16x16x32_bf16 v[156:159], v[108:111], v[36:39], v[156:159]
    v_mfma_f32_16x16x32_bf16 v[160:163], v[100:103], v[40:43], v[160:163]
    ds_read_b128 v[88:91], v16 offset:26624
    buffer_load_dwordx4 v12, s[24:27], s39 offen offset:1024 sc1 lds
    s_add_u32 s38, s38, 1024
    s_add_u32 s39, s39, 1024
    v_mfma_f32_16x16x32_bf16 v[164:167], v[104:107], v[40:43], v[164:167]
    v_mfma_f32_16x16x32_bf16 v[168:171], v[108:111], v[40:43], v[168:171]
    buffer_load_dwordx4 v12, s[24:27], s40 offen offset:2048 sc1 lds
    s_add_u32 s40, s40, 1024
    s_cmp_eq_u32 s42, 3
    s_movk_i32 s15, 13312
    s_cmovk_i32 s15, 38912
    s_cmov_b32 s42, 0
    s_add_u32 s41, s41, s15
    v_mfma_f32_16x16x32_bf16 v[172:175], v[100:103], v[44:47], v[172:175]
    ds_read_b128 v[92:95], v17 offset:24576
    v_mfma_f32_16x16x32_bf16 v[176:179], v[104:107], v[44:47], v[176:179]
    s_add_u32 m0, s52, 0
    s_add_u32 s54, s54, 1
    buffer_load_dwordx4 v14, s[16:19], s51 offen lds
    v_mfma_f32_16x16x32_bf16 v[180:183], v[108:111], v[44:47], v[180:183]
    v_mfma_f32_16x16x32_bf16 v[184:187], v[100:103], v[48:51], v[184:187]
    ds_read_b128 v[96:99], v17 offset:26624
    v_mfma_f32_16x16x32_bf16 v[188:191], v[104:107], v[48:51], v[188:191]
    v_mfma_f32_16x16x32_bf16 v[192:195], v[108:111], v[48:51], v[192:195]
    buffer_load_dwordx4 v[100:103], v34, s[28:31], s50 offen offset:0 sc1
    buffer_load_dwordx4 v[104:107], v34, s[28:31], s50 offen offset:1024 sc1
    buffer_load_dwordx4 v[108:111], v35, s[28:31], s50 offen offset:0 sc1
    s_add_u32 s50, s50, 98304
    s_waitcnt vmcnt(16) lgkmcnt(8)
    v_mfma_f32_16x16x32_bf16 v[148:151], v[112:115], v[52:55], v[148:151]
    v_mfma_f32_16x16x32_bf16 v[152:155], v[116:119], v[52:55], v[152:155]
    buffer_load_dwordx4 v15, s[16:19], s51 offen offset:1024 lds
    v_mfma_f32_16x16x32_bf16 v[156:159], v[120:123], v[52:55], v[156:159]
    v_mfma_f32_16x16x32_bf16 v[160:163], v[112:115], v[56:59], v[160:163]
    s_add_u32 m0, s52, 8192
    s_add_u32 s51, s51, 128
    buffer_load_dwordx4 v14, s[16:19], s51 offen lds
    v_mfma_f32_16x16x32_bf16 v[164:167], v[116:119], v[56:59], v[164:167]
    v_mfma_f32_16x16x32_bf16 v[168:171], v[120:123], v[56:59], v[168:171]
    buffer_load_dwordx4 v15, s[16:19], s51 offen offset:1024 lds
    v_mfma_f32_16x16x32_bf16 v[172:175], v[112:115], v[60:63], v[172:175]
    v_mfma_f32_16x16x32_bf16 v[176:179], v[116:119], v[60:63], v[176:179]
    s_add_u32 m0, s52, 16384
    s_add_u32 s51, s51, 128
    buffer_load_dwordx4 v14, s[16:19], s51 offen lds
    v_mfma_f32_16x16x32_bf16 v[180:183], v[120:123], v[60:63], v[180:183]
    v_mfma_f32_16x16x32_bf16 v[184:187], v[112:115], v[64:67], v[184:187]
    v_mfma_f32_16x16x32_bf16 v[188:191], v[116:119], v[64:67], v[188:191]
    v_mfma_f32_16x16x32_bf16 v[192:195], v[120:123], v[64:67], v[192:195]
    buffer_load_dwordx4 v[112:115], v34, s[28:31], s50 offen offset:0 sc1
    buffer_load_dwordx4 v[116:119], v34, s[28:31], s50 offen offset:1024 sc1
    buffer_load_dwordx4 v[120:123], v35, s[28:31], s50 offen offset:0 sc1
    s_add_u32 s50, s50, 98304
    s_waitcnt vmcnt(17) lgkmcnt(4)
    v_mfma_f32_16x16x32_bf16 v[148:151], v[124:127], v[68:71], v[148:151]
    v_mfma_f32_16x16x32_bf16 v[152:155], v[128:131], v[68:71], v[152:155]
    buffer_load_dwordx4 v15, s[16:19], s51 offen offset:1024 lds
    v_mfma_f32_16x16x32_bf16 v[156:159], v[132:135], v[68:71], v[156:159]
    v_mfma_f32_16x16x32_bf16 v[160:163], v[124:127], v[72:75], v[160:163]
    s_add_u32 m0, s52, 24576
    s_add_u32 s51, s51, 128
    buffer_load_dwordx4 v14, s[16:19], s51 offen lds
    v_mfma_f32_16x16x32_bf16 v[164:167], v[128:131], v[72:75], v[164:167]
    v_mfma_f32_16x16x32_bf16 v[168:171], v[132:135], v[72:75], v[168:171]
    buffer_load_dwordx4 v15, s[16:19], s51 offen offset:1024 lds
    s_add_u32 s51, s51, 128
    s_cmp_eq_u32 s54, 3
    s_cselect_b32 s15, s78, s77
    s_cmov_b32 s54, 0
    s_add_u32 s52, s52, s15
    v_mfma_f32_16x16x32_bf16 v[172:175], v[124:127], v[76:79], v[172:175]
    v_mfma_f32_16x16x32_bf16 v[176:179], v[128:131], v[76:79], v[176:179]
    v_mfma_f32_16x16x32_bf16 v[180:183], v[132:135], v[76:79], v[180:183]
    v_mfma_f32_16x16x32_bf16 v[184:187], v[124:127], v[80:83], v[184:187]
    v_mfma_f32_16x16x32_bf16 v[188:191], v[128:131], v[80:83], v[188:191]
    v_mfma_f32_16x16x32_bf16 v[192:195], v[132:135], v[80:83], v[192:195]
    buffer_load_dwordx4 v[124:127], v34, s[28:31], s50 offen offset:0 sc1
    buffer_load_dwordx4 v[128:131], v34, s[28:31], s50 offen offset:1024 sc1
    buffer_load_dwordx4 v[132:135], v35, s[28:31], s50 offen offset:0 sc1
    s_add_u32 s50, s50, 98304
    s_waitcnt vmcnt(20) lgkmcnt(0)
    v_mfma_f32_16x16x32_bf16 v[148:151], v[136:139], v[84:87], v[148:151]
    v_mfma_f32_16x16x32_bf16 v[152:155], v[140:143], v[84:87], v[152:155]
    v_mfma_f32_16x16x32_bf16 v[156:159], v[144:147], v[84:87], v[156:159]
    v_mfma_f32_16x16x32_bf16 v[160:163], v[136:139], v[88:91], v[160:163]
    v_mfma_f32_16x16x32_bf16 v[164:167], v[140:143], v[88:91], v[164:167]
    v_mfma_f32_16x16x32_bf16 v[168:171], v[144:147], v[88:91], v[168:171]
    v_mfma_f32_16x16x32_bf16 v[172:175], v[136:139], v[92:95], v[172:175]
    v_mfma_f32_16x16x32_bf16 v[176:179], v[140:143], v[92:95], v[176:179]
    v_mfma_f32_16x16x32_bf16 v[180:183], v[144:147], v[92:95], v[180:183]
    v_mfma_f32_16x16x32_bf16 v[184:187], v[136:139], v[96:99], v[184:187]
    v_mfma_f32_16x16x32_bf16 v[188:191], v[140:143], v[96:99], v[188:191]
    v_mfma_f32_16x16x32_bf16 v[192:195], v[144:147], v[96:99], v[192:195]
    buffer_load_dwordx4 v[136:139], v34, s[28:31], s50 offen offset:0 sc1
    buffer_load_dwordx4 v[140:143], v34, s[28:31], s50 offen offset:1024 sc1
    buffer_load_dwordx4 v[144:147], v35, s[28:31], s50 offen offset:0 sc1
    s_add_u32 s50, s50, 98304
    s_add_u32 s76, s76, 1
    s_cmp_eq_u32 s76, 3
    s_cselect_b32 s15, s78, s77
    s_cmov_b32 s76, 0
    v_add_u32 v16, s15, v16
    v_add_u32 v17, s15, v17
    s_cmp_eq_u32 s53, 8
    s_cbranch_scc1 K2G_wq
    s_cmp_eq_u32 s53, 9
    s_cbranch_scc1 K2G_wt
K2G_next:
    s_add_u32 s53, s53, 1
    s_cmp_lt_u32 s53, 12
    s_cbranch_scc1 K2G_stage
    s_setprio 1
    v_add_u32 v10, s66, v12
    s_xor_b32 s15, s12, 1
    s_mul_i32 s15, s15, 6144
    s_add_u32 s15, s15, 138240
    v_add_u32 v11, s15, v12
    s_nop 4
    ds_write_b128 v10, v[172:175] offset:0
    ds_write_b128 v10, v[176:179] offset:1024
    ds_write_b128 v10, v[180:183] offset:2048
    ds_write_b128 v10, v[184:187] offset:3072
    ds_write_b128 v10, v[188:191] offset:4096
    ds_write_b128 v10, v[192:195] offset:5120
    s_waitcnt lgkmcnt(0)
    s_barrier
    s_mov_b32 m0, s41
    s_add_u32 s42, s42, 1
    buffer_load_dwordx4 v12, s[24:27], s38 offen sc1 lds
    buffer_load_dwordx4 v12, s[24:27], s39 offen offset:1024 sc1 lds
    s_add_u32 s38, s38, 1024
    s_add_u32 s39, s39, 1024
    buffer_load_dwordx4 v12, s[24:27], s40 offen offset:2048 sc1 lds
    s_add_u32 s40, s40, 1024
    s_cmp_eq_u32 s42, 3
    s_movk_i32 s15, 13312
    s_cmovk_i32 s15, 38912
    s_cmov_b32 s42, 0
    s_add_u32 s41, s41, s15
    ds_read_b128 v[36:39], v11 offset:0
    ds_read_b128 v[40:43], v11 offset:1024
    ds_read_b128 v[44:47], v11 offset:2048
    ds_read_b128 v[48:51], v11 offset:3072
    ds_read_b128 v[52:55], v11 offset:4096
    ds_read_b128 v[56:59], v11 offset:5120
    s_mul_i32 s64, s48, 176
    s_lshl_b32 s64, s64, 10
    s_add_u32 s64, s64, 18874368
    s_mul_i32 s65, s49, 220
    s_lshl_b32 s65, s65, 10
    s_add_u32 s65, s65, 25165824
    s_mul_i32 s66, s12, 6
    s_add_u32 s66, s66, 20
    s_lshl_b32 s66, s66, 10
    s_lshl_b32 s67, s12, 12
    s_add_u32 s68, s12, 16
    s_lshl_b32 s68, s68, 10
    v_mov_b32 v5, v12
    v_add_u32 v6, 45056, v5
    v_add_u32 v7, 45056, v6
    v_add_u32 v8, 45056, v7
    v_add_u32 v9, 45056, v8
    v_lshlrev_b32 v11, 2, v2
    s_cmp_eq_u32 s73, 1
    s_cbranch_scc1 P3_pw_ok
    s_mul_i32 s15, s49, 5
    s_lshr_b32 s15, s15, 1
    s_lshl_b32 s15, s15, 8
    s_add_u32 s71, s15, 27209728
    s_mov_b32 s58, -1
    s_movk_i32 s59, 0xfff
    s_mov_b32 s72, 0
P3_pw_l:
    buffer_load_dword v16, v11, s[24:27], s71 offen offset:0 sc1
    buffer_load_dword v17, v11, s[24:27], s71 offen offset:256 sc1
    buffer_load_dword v18, v11, s[24:27], s71 offen offset:512 sc1
    s_add_u32 s72, s72, 1
    s_waitcnt vmcnt(0)
P3_pw_c:
    v_xor_b32 v16, s3, v16
    v_xor_b32 v17, s3, v17
    v_xor_b32 v18, s3, v18
    v_or3_b32 v16, v16, v17, v18
    v_cmp_ne_u32 vcc, 0, v16
    s_and_b64 vcc, vcc, s[58:59]
    s_cbranch_scc0 P3_pw_ok
    s_cmp_lt_u32 s72, 200000
    s_cbranch_scc0 P3_pw_ok
    s_sleep 6
    s_branch P3_pw_l
P3_pw_ok:
    s_add_u32 s69, s65, s66
    buffer_load_dwordx4 v[176:179], v5, s[24:27], s69 offen offset:0 sc1
    buffer_load_dwordx4 v[180:183], v6, s[24:27], s69 offen offset:0 sc1
    buffer_load_dwordx4 v[184:187], v7, s[24:27], s69 offen offset:0 sc1
    buffer_load_dwordx4 v[188:191], v8, s[24:27], s69 offen offset:0 sc1
    buffer_load_dwordx4 v[192:195], v9, s[24:27], s69 offen offset:0 sc1
    s_add_u32 s69, s65, s66
    buffer_load_dwordx4 v[196:199], v5, s[24:27], s69 offen offset:1024 sc1
    buffer_load_dwordx4 v[200:203], v6, s[24:27], s69 offen offset:1024 sc1
    buffer_load_dwordx4 v[204:207], v7, s[24:27], s69 offen offset:1024 sc1
    buffer_load_dwordx4 v[208:211], v8, s[24:27], s69 offen offset:1024 sc1
    buffer_load_dwordx4 v[212:215], v9, s[24:27], s69 offen offset:1024 sc1
    s_waitcnt lgkmcnt(0)
    v_lshlrev_b32 v32, 16, v32
    v_lshlrev_b32 v33, 16, v33
    v_add_f32 v148, v148, v32
    v_add_f32 v149, v149, v32
    v_add_f32 v150, v150, v32
    v_add_f32 v151, v151, v32
    v_add_f32 v148, v148, v36
    v_add_f32 v149, v149, v37
    v_add_f32 v150, v150, v38
    v_add_f32 v151, v151, v39
    v_lshlrev_b32 v14, 16, v20
    v_and_b32 v15, 0xffff0000, v20
    v_mul_f32 v148, v148, v14
    v_mul_f32 v149, v149, v15
    v_cvt_pk_bf16_f32 v68, v148, v149
    v_lshlrev_b32 v14, 16, v21
    v_and_b32 v15, 0xffff0000, v21
    v_mul_f32 v150, v150, v14
    v_mul_f32 v151, v151, v15
    v_cvt_pk_bf16_f32 v69, v150, v151
    v_add_f32 v152, v152, v32
    v_add_f32 v153, v153, v32
    v_add_f32 v154, v154, v32
    v_add_f32 v155, v155, v32
    v_add_f32 v152, v152, v40
    v_add_f32 v153, v153, v41
    v_add_f32 v154, v154, v42
    v_add_f32 v155, v155, v43
    v_lshlrev_b32 v14, 16, v22
    v_and_b32 v15, 0xffff0000, v22
    v_mul_f32 v152, v152, v14
    v_mul_f32 v153, v153, v15
    v_cvt_pk_bf16_f32 v70, v152, v153
    v_lshlrev_b32 v14, 16, v23
    v_and_b32 v15, 0xffff0000, v23
    v_mul_f32 v154, v154, v14
    v_mul_f32 v155, v155, v15
    v_cvt_pk_bf16_f32 v71, v154, v155
    v_add_f32 v156, v156, v32
    v_add_f32 v157, v157, v32
    v_add_f32 v158, v158, v32
    v_add_f32 v159, v159, v32
    v_add_f32 v156, v156, v44
    v_add_f32 v157, v157, v45
    v_add_f32 v158, v158, v46
    v_add_f32 v159, v159, v47
    v_lshlrev_b32 v14, 16, v24
    v_and_b32 v15, 0xffff0000, v24
    v_mul_f32 v156, v156, v14
    v_mul_f32 v157, v157, v15
    v_cvt_pk_bf16_f32 v76, v156, v157
    v_lshlrev_b32 v14, 16, v25
    v_and_b32 v15, 0xffff0000, v25
    v_mul_f32 v158, v158, v14
    v_mul_f32 v159, v159, v15
    v_cvt_pk_bf16_f32 v77, v158, v159
    v_add_f32 v160, v160, v33
    v_add_f32 v161, v161, v33
    v_add_f32 v162, v162, v33
    v_add_f32 v163, v163, v33
    v_add_f32 v160, v160, v48
    v_add_f32 v161, v161, v49
    v_add_f32 v162, v162, v50
    v_add_f32 v163, v163, v51
    v_lshlrev_b32 v14, 16, v26
    v_and_b32 v15, 0xffff0000, v26
    v_mul_f32 v160, v160, v14
    v_mul_f32 v161, v161, v15
    v_cvt_pk_bf16_f32 v72, v160, v161
    v_lshlrev_b32 v14, 16, v27
    v_and_b32 v15, 0xffff0000, v27
    v_mul_f32 v162, v162, v14
    v_mul_f32 v163, v163, v15
    v_cvt_pk_bf16_f32 v73, v162, v163
    v_add_f32 v164, v164, v33
    v_add_f32 v165, v165, v33
    v_add_f32 v166, v166, v33
    v_add_f32 v167, v167, v33
    v_add_f32 v164, v164, v52
    v_add_f32 v165, v165, v53
    v_add_f32 v166, v166, v54
    v_add_f32 v167, v167, v55
    v_lshlrev_b32 v14, 16, v28
    v_and_b32 v15, 0xffff0000, v28
    v_mul_f32 v164, v164, v14
    v_mul_f32 v165, v165, v15
    v_cvt_pk_bf16_f32 v74, v164, v165
    v_lshlrev_b32 v14, 16, v29
    v_and_b32 v15, 0xffff0000, v29
    v_mul_f32 v166, v166, v14
    v_mul_f32 v167, v167, v15
    v_cvt_pk_bf16_f32 v75, v166, v167
    v_add_f32 v168, v168, v33
    v_add_f32 v169, v169, v33
    v_add_f32 v170, v170, v33
    v_add_f32 v171, v171, v33
    v_add_f32 v168, v168, v56
    v_add_f32 v169, v169, v57
    v_add_f32 v170, v170, v58
    v_add_f32 v171, v171, v59
    v_lshlrev_b32 v14, 16, v30
    v_and_b32 v15, 0xffff0000, v30
    v_mul_f32 v168, v168, v14
    v_mul_f32 v169, v169, v15
    v_cvt_pk_bf16_f32 v78, v168, v169
    v_lshlrev_b32 v14, 16, v31
    v_and_b32 v15, 0xffff0000, v31
    v_mul_f32 v170, v170, v14
    v_mul_f32 v171, v171, v15
    v_cvt_pk_bf16_f32 v79, v170, v171
    s_mul_i32 s61, s49, 3
    s_mul_i32 s43, s60, 88
    s_add_u32 s61, s61, s43
    s_lshl_b32 s15, s57, 1
    s_add_u32 s15, s15, s61
    s_lshl_b32 s15, s15, 10
    s_add_u32 s59, s15, 18894848
    buffer_store_dwordx4 v[68:71], v12, s[24:27], s59 offen sc1
    s_add_u32 s59, s59, 45056
    buffer_store_dwordx4 v[72:75], v12, s[24:27], s59 offen sc1
    s_mul_i32 s15, s57, 44
    s_add_u32 s15, s15, s61
    s_lshl_b32 s15, s15, 10
    s_add_u32 s59, s15, 18895872
    buffer_store_dwordx4 v[76:79], v12, s[24:27], s59 offen sc1
    s_waitcnt vmcnt(13)
    s_barrier
    s_add_u32 s69, s65, s66
    buffer_load_dwordx4 v[216:219], v5, s[24:27], s69 offen offset:2048 sc1
    buffer_load_dwordx4 v[220:223], v6, s[24:27], s69 offen offset:2048 sc1
    buffer_load_dwordx4 v[224:227], v7, s[24:27], s69 offen offset:2048 sc1
    buffer_load_dwordx4 v[228:231], v8, s[24:27], s69 offen offset:2048 sc1
    buffer_load_dwordx4 v[232:235], v9, s[24:27], s69 offen offset:2048 sc1
    s_add_u32 s69, s65, s66
    buffer_load_dwordx4 v[236:239], v5, s[24:27], s69 offen offset:3072 sc1
    buffer_load_dwordx4 v[240:243], v6, s[24:27], s69 offen offset:3072 sc1
    buffer_load_dwordx4 v[244:247], v7, s[24:27], s69 offen offset:3072 sc1
    buffer_load_dwordx4 v[248:251], v8, s[24:27], s69 offen offset:3072 sc1
    buffer_load_dwordx4 v[252:255], v9, s[24:27], s69 offen offset:3072 sc1
    s_lshl_b32 s70, s48, 9
    s_add_u32 s70, s70, 27230208
    s_lshr_b32 s15, s49, 1
    s_lshl_b32 s15, s15, 7
    s_add_u32 s71, s70, s15
    s_and_b32 s15, s49, 1
    s_lshl_b32 s15, s15, 2
    s_add_u32 s15, s15, s12
    s_lshl_b32 s15, s15, 2
    s_add_u32 s71, s71, s15
    s_lshl_b32 s15, s12, 7
    s_add_u32 s70, s70, s15
    v_mov_b32 v10, s3
    s_mov_b64 exec, 1
    s_waitcnt vmcnt(10)
    buffer_store_dword v10, v11, s[24:27], s71 offen sc1
    s_mov_b64 exec, -1
    s_mov_b32 s16, s62
    s_and_b32 s17, s63, 0xffff
    s_mov_b32 s18, 2621440
    s_mov_b32 s19, 0x00020000
    s_mov_b32 s20, s74
    s_and_b32 s21, s75, 0xffff
    s_mov_b32 s22, 2621440
    s_mov_b32 s23, 0x00020000
    s_lshl_b32 s40, s48, 6
    s_mul_i32 s40, s40, 1280
    s_mul_i32 s15, s49, 160
    s_add_u32 s40, s40, s15
    s_mov_b32 s41, 0x1999999A
    v_add_u32 v32, -256, v0
    v_mul_hi_u32 v33, v32, s41
    v_mul_u32_u24 v34, 10, v33
    v_sub_u32 v32, v32, v34
    v_mul_u32_u24 v34, 1280, v33
    v_lshl_add_u32 v26, v32, 4, v34
    v_mul_u32_u24 v34, 336, v33
    v_lshl_add_u32 v29, v32, 4, v34
    v_add_u32 v32, 0, v0
    v_mul_hi_u32 v33, v32, s41
    v_mul_u32_u24 v34, 10, v33
    v_sub_u32 v32, v32, v34
    v_mul_u32_u24 v34, 1280, v33
    v_lshl_add_u32 v27, v32, 4, v34
    v_mul_u32_u24 v34, 336, v33
    v_lshl_add_u32 v30, v32, 4, v34
    v_add_u32 v32, 256, v0
    v_mul_hi_u32 v33, v32, s41
    v_mul_u32_u24 v34, 10, v33
    v_sub_u32 v32, v32, v34
    v_mul_u32_u24 v34, 1280, v33
    v_lshl_add_u32 v28, v32, 4, v34
    v_mul_u32_u24 v34, 336, v33
    v_lshl_add_u32 v31, v32, 4, v34
    v_cmp_gt_u32 vcc, 64, v33
    v_mov_b32 v34, 0x7fffffff
    s_nop 0
    v_cndmask_b32 v28, v34, v28, vcc
    v_cndmask_b32 v31, 0, v31, vcc
    v_add_u32 v29, 39936, v29
    buffer_load_dwordx4 v[14:17], v26, s[16:19], s40 offen
    v_add_u32 v30, 39936, v30
    buffer_load_dwordx4 v[18:21], v27, s[16:19], s40 offen
    v_add_u32 v31, 39936, v31
    buffer_load_dwordx4 v[22:25], v28, s[16:19], s40 offen
    s_mul_i32 s39, s12, 21504
    s_add_u32 s39, s39, 39936
    s_add_u32 s69, s65, s67
    s_add_u32 s69, s69, 3072
    s_add_u32 m0, s39, 0
    s_nop 0
    buffer_load_dwordx4 v5, s[24:27], s69 offen sc1 lds
    s_add_u32 m0, s39, 1024
    s_nop 0
    buffer_load_dwordx4 v6, s[24:27], s69 offen sc1 lds
    s_add_u32 m0, s39, 2048
    s_nop 0
    buffer_load_dwordx4 v7, s[24:27], s69 offen sc1 lds
    s_add_u32 m0, s39, 3072
    s_nop 0
    buffer_load_dwordx4 v8, s[24:27], s69 offen sc1 lds
    s_add_u32 m0, s39, 4096
    s_nop 0
    buffer_load_dwordx4 v9, s[24:27], s69 offen sc1 lds
    s_add_u32 s69, s65, s68
    s_add_u32 m0, s39, 5120
    s_nop 0
    buffer_load_dwordx4 v5, s[24:27], s69 offen sc1 lds
    s_add_u32 m0, s39, 6144
    s_nop 0
    buffer_load_dwordx4 v6, s[24:27], s69 offen sc1 lds
    s_add_u32 m0, s39, 7168
    s_nop 0
    buffer_load_dwordx4 v7, s[24:27], s69 offen sc1 lds
    s_add_u32 m0, s39, 8192
    s_nop 0
    buffer_load_dwordx4 v8, s[24:27], s69 offen sc1 lds
    s_add_u32 m0, s39, 9216
    s_nop 0
    buffer_load_dwordx4 v9, s[24:27], s69 offen sc1 lds
    s_setprio 0
    s_mov_b64 exec, 0xff
    s_mov_b32 s72, 0
P3_pu_l:
    buffer_load_dword v10, v11, s[24:27], s70 offen offset:0 sc1
    s_add_u32 s72, s72, 1
    s_waitcnt vmcnt(0)
P3_pu_c:
    v_cmp_ne_u32 vcc, s3, v10
    s_and_b64 vcc, vcc, exec
    s_cbranch_scc0 P3_pu_ok
    s_cmp_lt_u32 s72, 200000
    s_cbranch_scc0 P3_pu_ok
    s_sleep 6
    s_branch P3_pu_l
P3_pu_ok:
    s_mov_b64 exec, -1
    s_add_u32 s69, s64, s66
    buffer_load_dwordx4 v[112:115], v5, s[24:27], s69 offen offset:0 sc1
    buffer_load_dwordx4 v[116:119], v6, s[24:27], s69 offen offset:0 sc1
    buffer_load_dwordx4 v[120:123], v7, s[24:27], s69 offen offset:0 sc1
    buffer_load_dwordx4 v[124:127], v8, s[24:27], s69 offen offset:0 sc1
    s_add_u32 s69, s64, s66
    buffer_load_dwordx4 v[128:131], v5, s[24:27], s69 offen offset:1024 sc1
    buffer_load_dwordx4 v[132:135], v6, s[24:27], s69 offen offset:1024 sc1
    buffer_load_dwordx4 v[136:139], v7, s[24:27], s69 offen offset:1024 sc1
    buffer_load_dwordx4 v[140:143], v8, s[24:27], s69 offen offset:1024 sc1
    s_add_u32 s69, s64, s66
    buffer_load_dwordx4 v[144:147], v5, s[24:27], s69 offen offset:2048 sc1
    buffer_load_dwordx4 v[148:151], v6, s[24:27], s69 offen offset:2048 sc1
    buffer_load_dwordx4 v[152:155], v7, s[24:27], s69 offen offset:2048 sc1
    buffer_load_dwordx4 v[156:159], v8, s[24:27], s69 offen offset:2048 sc1
    s_add_u32 s69, s64, s66
    buffer_load_dwordx4 v[160:163], v5, s[24:27], s69 offen offset:3072 sc1
    buffer_load_dwordx4 v[164:167], v6, s[24:27], s69 offen offset:3072 sc1
    buffer_load_dwordx4 v[168:171], v7, s[24:27], s69 offen offset:3072 sc1
    buffer_load_dwordx4 v[172:175], v8, s[24:27], s69 offen offset:3072 sc1
    s_waitcnt vmcnt(12)
    v_mfma_f32_16x16x32_bf16 v[32:35], v[176:179], v[112:115], 0
    v_mfma_f32_16x16x32_bf16 v[36:39], v[176:179], v[116:119], 0
    v_mfma_f32_16x16x32_bf16 v[40:43], v[176:179], v[120:123], 0
    v_mfma_f32_16x16x32_bf16 v[44:47], v[176:179], v[124:127], 0
    v_mfma_f32_16x16x32_bf16 v[48:51], v[180:183], v[112:115], 0
    v_mfma_f32_16x16x32_bf16 v[52:55], v[180:183], v[116:119], 0
    v_mfma_f32_16x16x32_bf16 v[56:59], v[180:183], v[120:123], 0
    v_mfma_f32_16x16x32_bf16 v[60:63], v[180:183], v[124:127], 0
    v_mfma_f32_16x16x32_bf16 v[64:67], v[184:187], v[112:115], 0
    v_mfma_f32_16x16x32_bf16 v[68:71], v[184:187], v[116:119], 0
    v_mfma_f32_16x16x32_bf16 v[72:75], v[184:187], v[120:123], 0
    v_mfma_f32_16x16x32_bf16 v[76:79], v[184:187], v[124:127], 0
    v_mfma_f32_16x16x32_bf16 v[80:83], v[188:191], v[112:115], 0
    v_mfma_f32_16x16x32_bf16 v[84:87], v[188:191], v[116:119], 0
    v_mfma_f32_16x16x32_bf16 v[88:91], v[188:191], v[120:123], 0
    v_mfma_f32_16x16x32_bf16 v[92:95], v[188:191], v[124:127], 0
    v_mfma_f32_16x16x32_bf16 v[96:99], v[192:195], v[112:115], 0
    v_mfma_f32_16x16x32_bf16 v[100:103], v[192:195], v[116:119], 0
    v_mfma_f32_16x16x32_bf16 v[104:107], v[192:195], v[120:123], 0
    v_mfma_f32_16x16x32_bf16 v[108:111], v[192:195], v[124:127], 0
    s_add_u32 s69, s64, s66
    s_add_u32 s69, s69, 4096
    buffer_load_dwordx4 v[112:115], v5, s[24:27], s69 offen offset:0 sc1
    buffer_load_dwordx4 v[116:119], v6, s[24:27], s69 offen offset:0 sc1
    buffer_load_dwordx4 v[120:123], v7, s[24:27], s69 offen offset:0 sc1
    buffer_load_dwordx4 v[124:127], v8, s[24:27], s69 offen offset:0 sc1
    s_add_u32 s69, s65, s66
    s_add_u32 s69, s69, 4096
    buffer_load_dwordx4 v[176:179], v5, s[24:27], s69 offen offset:0 sc1
    buffer_load_dwordx4 v[180:183], v6, s[24:27], s69 offen offset:0 sc1
    buffer_load_dwordx4 v[184:187], v7, s[24:27], s69 offen offset:0 sc1
    buffer_load_dwordx4 v[188:191], v8, s[24:27], s69 offen offset:0 sc1
    buffer_load_dwordx4 v[192:195], v9, s[24:27], s69 offen offset:0 sc1
    s_waitcnt vmcnt(17)
    v_swap_b32 v130, v132
    v_swap_b32 v131, v133
    v_swap_b32 v138, v140
    v_swap_b32 v139, v141
    s_nop 1
    v_mfma_f32_16x16x32_bf16 v[32:35], v[196:199], v[128:131], v[32:35]
    v_mfma_f32_16x16x32_bf16 v[36:39], v[196:199], v[132:135], v[36:39]
    v_mfma_f32_16x16x32_bf16 v[40:43], v[196:199], v[136:139], v[40:43]
    v_mfma_f32_16x16x32_bf16 v[44:47], v[196:199], v[140:143], v[44:47]
    v_mfma_f32_16x16x32_bf16 v[48:51], v[200:203], v[128:131], v[48:51]
    v_mfma_f32_16x16x32_bf16 v[52:55], v[200:203], v[132:135], v[52:55]
    v_mfma_f32_16x16x32_bf16 v[56:59], v[200:203], v[136:139], v[56:59]
    v_mfma_f32_16x16x32_bf16 v[60:63], v[200:203], v[140:143], v[60:63]
    v_mfma_f32_16x16x32_bf16 v[64:67], v[204:207], v[128:131], v[64:67]
    v_mfma_f32_16x16x32_bf16 v[68:71], v[204:207], v[132:135], v[68:71]
    v_mfma_f32_16x16x32_bf16 v[72:75], v[204:207], v[136:139], v[72:75]
    v_mfma_f32_16x16x32_bf16 v[76:79], v[204:207], v[140:143], v[76:79]
    v_mfma_f32_16x16x32_bf16 v[80:83], v[208:211], v[128:131], v[80:83]
    v_mfma_f32_16x16x32_bf16 v[84:87], v[208:211], v[132:135], v[84:87]
    v_mfma_f32_16x16x32_bf16 v[88:91], v[208:211], v[136:139], v[88:91]
    v_mfma_f32_16x16x32_bf16 v[92:95], v[208:211], v[140:143], v[92:95]
    v_mfma_f32_16x16x32_bf16 v[96:99], v[212:215], v[128:131], v[96:99]
    v_mfma_f32_16x16x32_bf16 v[100:103], v[212:215], v[132:135], v[100:103]
    v_mfma_f32_16x16x32_bf16 v[104:107], v[212:215], v[136:139], v[104:107]
    v_mfma_f32_16x16x32_bf16 v[108:111], v[212:215], v[140:143], v[108:111]
    s_add_u32 s69, s64, s66
    s_add_u32 s69, s69, 4096
    buffer_load_dwordx4 v[128:131], v5, s[24:27], s69 offen offset:1024 sc1
    buffer_load_dwordx4 v[132:135], v6, s[24:27], s69 offen offset:1024 sc1
    buffer_load_dwordx4 v[136:139], v7, s[24:27], s69 offen offset:1024 sc1
    buffer_load_dwordx4 v[140:143], v8, s[24:27], s69 offen offset:1024 sc1
    s_add_u32 s69, s65, s66
    s_add_u32 s69, s69, 4096
    buffer_load_dwordx4 v[196:199], v5, s[24:27], s69 offen offset:1024 sc1
    buffer_load_dwordx4 v[200:203], v6, s[24:27], s69 offen offset:1024 sc1
    buffer_load_dwordx4 v[204:207], v7, s[24:27], s69 offen offset:1024 sc1
    buffer_load_dwordx4 v[208:211], v8, s[24:27], s69 offen offset:1024 sc1
    buffer_load_dwordx4 v[212:215], v9, s[24:27], s69 offen offset:1024 sc1
    s_waitcnt vmcnt(22)
    v_mfma_f32_16x16x32_bf16 v[32:35], v[216:219], v[144:147], v[32:35]
    v_mfma_f32_16x16x32_bf16 v[36:39], v[216:219], v[148:151], v[36:39]
    v_mfma_f32_16x16x32_bf16 v[40:43], v[216:219], v[152:155], v[40:43]
    v_mfma_f32_16x16x32_bf16 v[44:47], v[216:219], v[156:159], v[44:47]
    v_mfma_f32_16x16x32_bf16 v[48:51], v[220:223], v[144:147], v[48:51]
    v_mfma_f32_16x16x32_bf16 v[52:55], v[220:223], v[148:151], v[52:55]
    v_mfma_f32_16x16x32_bf16 v[56:59], v[220:223], v[152:155], v[56:59]
    v_mfma_f32_16x16x32_bf16 v[60:63], v[220:223], v[156:159], v[60:63]
    v_mfma_f32_16x16x32_bf16 v[64:67], v[224:227], v[144:147], v[64:67]
    v_mfma_f32_16x16x32_bf16 v[68:71], v[224:227], v[148:151], v[68:71]
    v_mfma_f32_16x16x32_bf16 v[72:75], v[224:227], v[152:155], v[72:75]
    v_mfma_f32_16x16x32_bf16 v[76:79], v[224:227], v[156:159], v[76:79]
    v_mfma_f32_16x16x32_bf16 v[80:83], v[228:231], v[144:147], v[80:83]
    v_mfma_f32_16x16x32_bf16 v[84:87], v[228:231], v[148:151], v[84:87]
    v_mfma_f32_16x16x32_bf16 v[88:91], v[228:231], v[152:155], v[88:91]
    v_mfma_f32_16x16x32_bf16 v[92:95], v[228:231], v[156:159], v[92:95]
    v_mfma_f32_16x16x32_bf16 v[96:99], v[232:235], v[144:147], v[96:99]
    v_mfma_f32_16x16x32_bf16 v[100:103], v[232:235], v[148:151], v[100:103]
    v_mfma_f32_16x16x32_bf16 v[104:107], v[232:235], v[152:155], v[104:107]
    v_mfma_f32_16x16x32_bf16 v[108:111], v[232:235], v[156:159], v[108:111]
    s_add_u32 s69, s65, s67
    buffer_load_dwordx4 v[216:219], v5, s[24:27], s69 offen offset:0 sc1
    buffer_load_dwordx4 v[220:223], v6, s[24:27], s69 offen offset:0 sc1
    buffer_load_dwordx4 v[224:227], v7, s[24:27], s69 offen offset:0 sc1
    buffer_load_dwordx4 v[228:231], v8, s[24:27], s69 offen offset:0 sc1
    buffer_load_dwordx4 v[232:235], v9, s[24:27], s69 offen offset:0 sc1
    s_waitcnt vmcnt(23)
    v_mfma_f32_16x16x32_bf16 v[32:35], v[236:239], v[160:163], v[32:35]
    v_mfma_f32_16x16x32_bf16 v[36:39], v[236:239], v[164:167], v[36:39]
    v_mfma_f32_16x16x32_bf16 v[40:43], v[236:239], v[168:171], v[40:43]
    v_mfma_f32_16x16x32_bf16 v[44:47], v[236:239], v[172:175], v[44:47]
    v_mfma_f32_16x16x32_bf16 v[48:51], v[240:243], v[160:163], v[48:51]
    v_mfma_f32_16x16x32_bf16 v[52:55], v[240:243], v[164:167], v[52:55]
    v_mfma_f32_16x16x32_bf16 v[56:59], v[240:243], v[168:171], v[56:59]
    v_mfma_f32_16x16x32_bf16 v[60:63], v[240:243], v[172:175], v[60:63]
    v_mfma_f32_16x16x32_bf16 v[64:67], v[244:247], v[160:163], v[64:67]
    v_mfma_f32_16x16x32_bf16 v[68:71], v[244:247], v[164:167], v[68:71]
    v_mfma_f32_16x16x32_bf16 v[72:75], v[244:247], v[168:171], v[72:75]
    v_mfma_f32_16x16x32_bf16 v[76:79], v[244:247], v[172:175], v[76:79]
    v_mfma_f32_16x16x32_bf16 v[80:83], v[248:251], v[160:163], v[80:83]
    v_mfma_f32_16x16x32_bf16 v[84:87], v[248:251], v[164:167], v[84:87]
    v_mfma_f32_16x16x32_bf16 v[88:91], v[248:251], v[168:171], v[88:91]
    v_mfma_f32_16x16x32_bf16 v[92:95], v[248:251], v[172:175], v[92:95]
    v_mfma_f32_16x16x32_bf16 v[96:99], v[252:255], v[160:163], v[96:99]
    v_mfma_f32_16x16x32_bf16 v[100:103], v[252:255], v[164:167], v[100:103]
    v_mfma_f32_16x16x32_bf16 v[104:107], v[252:255], v[168:171], v[104:107]
    v_mfma_f32_16x16x32_bf16 v[108:111], v[252:255], v[172:175], v[108:111]
    s_add_u32 s69, s65, s67
    buffer_load_dwordx4 v[236:239], v5, s[24:27], s69 offen offset:1024 sc1
    buffer_load_dwordx4 v[240:243], v6, s[24:27], s69 offen offset:1024 sc1
    buffer_load_dwordx4 v[244:247], v7, s[24:27], s69 offen offset:1024 sc1
    buffer_load_dwordx4 v[248:251], v8, s[24:27], s69 offen offset:1024 sc1
    buffer_load_dwordx4 v[252:255], v9, s[24:27], s69 offen offset:1024 sc1
    s_waitcnt vmcnt(19)
    v_swap_b32 v114, v116
    v_swap_b32 v115, v117
    v_swap_b32 v122, v124
    v_swap_b32 v123, v125
    s_nop 1
    v_mfma_f32_16x16x32_bf16 v[32:35], v[176:179], v[112:115], v[32:35]
    v_mfma_f32_16x16x32_bf16 v[36:39], v[176:179], v[116:119], v[36:39]
    v_mfma_f32_16x16x32_bf16 v[40:43], v[176:179], v[120:123], v[40:43]
    v_mfma_f32_16x16x32_bf16 v[44:47], v[176:179], v[124:127], v[44:47]
    v_mfma_f32_16x16x32_bf16 v[48:51], v[180:183], v[112:115], v[48:51]
    v_mfma_f32_16x16x32_bf16 v[52:55], v[180:183], v[116:119], v[52:55]
    v_mfma_f32_16x16x32_bf16 v[56:59], v[180:183], v[120:123], v[56:59]
    v_mfma_f32_16x16x32_bf16 v[60:63], v[180:183], v[124:127], v[60:63]
    v_mfma_f32_16x16x32_bf16 v[64:67], v[184:187], v[112:115], v[64:67]
    v_mfma_f32_16x16x32_bf16 v[68:71], v[184:187], v[116:119], v[68:71]
    v_mfma_f32_16x16x32_bf16 v[72:75], v[184:187], v[120:123], v[72:75]
    v_mfma_f32_16x16x32_bf16 v[76:79], v[184:187], v[124:127], v[76:79]
    v_mfma_f32_16x16x32_bf16 v[80:83], v[188:191], v[112:115], v[80:83]
    v_mfma_f32_16x16x32_bf16 v[84:87], v[188:191], v[116:119], v[84:87]
    v_mfma_f32_16x16x32_bf16 v[88:91], v[188:191], v[120:123], v[88:91]
    v_mfma_f32_16x16x32_bf16 v[92:95], v[188:191], v[124:127], v[92:95]
    v_mfma_f32_16x16x32_bf16 v[96:99], v[192:195], v[112:115], v[96:99]
    v_mfma_f32_16x16x32_bf16 v[100:103], v[192:195], v[116:119], v[100:103]
    v_mfma_f32_16x16x32_bf16 v[104:107], v[192:195], v[120:123], v[104:107]
    v_mfma_f32_16x16x32_bf16 v[108:111], v[192:195], v[124:127], v[108:111]
    s_add_u32 s69, s65, s67
    buffer_load_dwordx4 v[176:179], v5, s[24:27], s69 offen offset:2048 sc1
    buffer_load_dwordx4 v[180:183], v6, s[24:27], s69 offen offset:2048 sc1
    buffer_load_dwordx4 v[184:187], v7, s[24:27], s69 offen offset:2048 sc1
    buffer_load_dwordx4 v[188:191], v8, s[24:27], s69 offen offset:2048 sc1
    buffer_load_dwordx4 v[192:195], v9, s[24:27], s69 offen offset:2048 sc1
    s_waitcnt vmcnt(15)
    v_mfma_f32_16x16x32_bf16 v[32:35], v[196:199], v[128:131], v[32:35]
    v_mfma_f32_16x16x32_bf16 v[36:39], v[196:199], v[132:135], v[36:39]
    v_mfma_f32_16x16x32_bf16 v[40:43], v[196:199], v[136:139], v[40:43]
    v_mfma_f32_16x16x32_bf16 v[44:47], v[196:199], v[140:143], v[44:47]
    v_mfma_f32_16x16x32_bf16 v[48:51], v[200:203], v[128:131], v[48:51]
    v_mfma_f32_16x16x32_bf16 v[52:55], v[200:203], v[132:135], v[52:55]
    v_mfma_f32_16x16x32_bf16 v[56:59], v[200:203], v[136:139], v[56:59]
    v_mfma_f32_16x16x32_bf16 v[60:63], v[200:203], v[140:143], v[60:63]
    v_mfma_f32_16x16x32_bf16 v[64:67], v[204:207], v[128:131], v[64:67]
    v_mfma_f32_16x16x32_bf16 v[68:71], v[204:207], v[132:135], v[68:71]
    v_mfma_f32_16x16x32_bf16 v[72:75], v[204:207], v[136:139], v[72:75]
    v_mfma_f32_16x16x32_bf16 v[76:79], v[204:207], v[140:143], v[76:79]
    v_mfma_f32_16x16x32_bf16 v[80:83], v[208:211], v[128:131], v[80:83]
    v_mfma_f32_16x16x32_bf16 v[84:87], v[208:211], v[132:135], v[84:87]
    v_mfma_f32_16x16x32_bf16 v[88:91], v[208:211], v[136:139], v[88:91]
    v_mfma_f32_16x16x32_bf16 v[92:95], v[208:211], v[140:143], v[92:95]
    v_mfma_f32_16x16x32_bf16 v[96:99], v[212:215], v[128:131], v[96:99]
    v_mfma_f32_16x16x32_bf16 v[100:103], v[212:215], v[132:135], v[100:103]
    v_mfma_f32_16x16x32_bf16 v[104:107], v[212:215], v[136:139], v[104:107]
    v_mfma_f32_16x16x32_bf16 v[108:111], v[212:215], v[140:143], v[108:111]
    v_and_b32 v1, 15, v2
    v_lshrrev_b32 v3, 4, v2
    v_mul_u32_u24 v4, 336, v1
    v_lshrrev_b32 v10, 1, v3
    v_lshl_add_u32 v4, v10, 4, v4
    v_and_b32 v10, 1, v3
    v_mul_u32_u24 v10, 160, v10
    v_add_u32 v4, v4, v10
    s_mul_i32 s15, s12, 21504
    s_add_u32 s15, s15, 39936
    v_add_u32 v4, s15, v4
    v_lshlrev_b32 v1, 4, v1
    v_lshl_add_u32 v1, v3, 10, v1
    v_add_u32 v3, s39, v12
    s_lshl_b32 s38, s48, 14
    s_lshl_b32 s15, s12, 12
    s_add_u32 s38, s38, s15
    s_add_u32 s38, s38, 24641536
    s_add_u32 s70, s70, 16384
    s_mov_b64 exec, 0xff
    s_mov_b32 s72, 0
P3_po_l:
    buffer_load_dword v10, v11, s[24:27], s70 offen offset:0 sc1
    s_add_u32 s72, s72, 1
    s_waitcnt vmcnt(0)
P3_po_c:
    v_cmp_ne_u32 vcc, s3, v10
    s_and_b64 vcc, vcc, exec
    s_cbranch_scc0 P3_po_ok
    s_cmp_lt_u32 s72, 200000
    s_cbranch_scc0 P3_po_ok
    s_sleep 6
    s_branch P3_po_l
P3_po_ok:
    s_mov_b64 exec, -1
    v_mov_b32 v10, v1
    s_add_u32 s69, s64, s67
    buffer_load_dwordx4 v[144:147], v5, s[24:27], s69 offen offset:0 sc1
    buffer_load_dwordx4 v[148:151], v6, s[24:27], s69 offen offset:0 sc1
    buffer_load_dwordx4 v[152:155], v7, s[24:27], s69 offen offset:0 sc1
    buffer_load_dwordx4 v[156:159], v8, s[24:27], s69 offen offset:0 sc1
    s_add_u32 s69, s64, s67
    buffer_load_dwordx4 v[160:163], v5, s[24:27], s69 offen offset:1024 sc1
    buffer_load_dwordx4 v[164:167], v6, s[24:27], s69 offen offset:1024 sc1
    buffer_load_dwordx4 v[168:171], v7, s[24:27], s69 offen offset:1024 sc1
    buffer_load_dwordx4 v[172:175], v8, s[24:27], s69 offen offset:1024 sc1
    s_add_u32 s69, s64, s67
    buffer_load_dwordx4 v[112:115], v5, s[24:27], s69 offen offset:2048 sc1
    buffer_load_dwordx4 v[116:119], v6, s[24:27], s69 offen offset:2048 sc1
    buffer_load_dwordx4 v[120:123], v7, s[24:27], s69 offen offset:2048 sc1
    buffer_load_dwordx4 v[124:127], v8, s[24:27], s69 offen offset:2048 sc1
    s_add_u32 s69, s64, s67
    buffer_load_dwordx4 v[128:131], v5, s[24:27], s69 offen offset:3072 sc1
    buffer_load_dwordx4 v[132:135], v6, s[24:27], s69 offen offset:3072 sc1
    buffer_load_dwordx4 v[136:139], v7, s[24:27], s69 offen offset:3072 sc1
    buffer_load_dwordx4 v[140:143], v8, s[24:27], s69 offen offset:3072 sc1
    buffer_load_dwordx4 v[196:199], v10, s[24:27], s38 offen offset:0 sc1
    buffer_load_dwordx4 v[200:203], v10, s[24:27], s38 offen offset:512 sc1
    buffer_load_dwordx4 v[204:207], v10, s[24:27], s38 offen offset:256 sc1
    buffer_load_dwordx4 v[208:211], v10, s[24:27], s38 offen offset:768 sc1
    s_waitcnt vmcnt(16)
    v_mfma_f32_16x16x32_bf16 v[32:35], v[216:219], v[144:147], v[32:35]
    v_mfma_f32_16x16x32_bf16 v[36:39], v[216:219], v[148:151], v[36:39]
    v_mfma_f32_16x16x32_bf16 v[40:43], v[216:219], v[152:155], v[40:43]
    v_mfma_f32_16x16x32_bf16 v[44:47], v[216:219], v[156:159], v[44:47]
    v_mfma_f32_16x16x32_bf16 v[48:51], v[220:223], v[144:147], v[48:51]
    v_mfma_f32_16x16x32_bf16 v[52:55], v[220:223], v[148:151], v[52:55]
    v_mfma_f32_16x16x32_bf16 v[56:59], v[220:223], v[152:155], v[56:59]
    v_mfma_f32_16x16x32_bf16 v[60:63], v[220:223], v[156:159], v[60:63]
    v_mfma_f32_16x16x32_bf16 v[64:67], v[224:227], v[144:147], v[64:67]
    v_mfma_f32_16x16x32_bf16 v[68:71], v[224:227], v[148:151], v[68:71]
    v_mfma_f32_16x16x32_bf16 v[72:75], v[224:227], v[152:155], v[72:75]
    v_mfma_f32_16x16x32_bf16 v[76:79], v[224:227], v[156:159], v[76:79]
    v_mfma_f32_16x16x32_bf16 v[80:83], v[228:231], v[144:147], v[80:83]
    v_mfma_f32_16x16x32_bf16 v[84:87], v[228:231], v[148:151], v[84:87]
    v_mfma_f32_16x16x32_bf16 v[88:91], v[228:231], v[152:155], v[88:91]
    v_mfma_f32_16x16x32_bf16 v[92:95], v[228:231], v[156:159], v[92:95]
    v_mfma_f32_16x16x32_bf16 v[96:99], v[232:235], v[144:147], v[96:99]
    v_mfma_f32_16x16x32_bf16 v[100:103], v[232:235], v[148:151], v[100:103]
    v_mfma_f32_16x16x32_bf16 v[104:107], v[232:235], v[152:155], v[104:107]
    v_mfma_f32_16x16x32_bf16 v[108:111], v[232:235], v[156:159], v[108:111]
    ds_read_b128 v[216:219], v3 offset:0
    ds_read_b128 v[220:223], v3 offset:1024
    ds_read_b128 v[224:227], v3 offset:2048
    ds_read_b128 v[228:231], v3 offset:3072
    ds_read_b128 v[232:235], v3 offset:4096
    s_waitcnt vmcnt(12)
    v_mfma_f32_16x16x32_bf16 v[32:35], v[236:239], v[160:163], v[32:35]
    v_mfma_f32_16x16x32_bf16 v[36:39], v[236:239], v[164:167], v[36:39]
    v_mfma_f32_16x16x32_bf16 v[40:43], v[236:239], v[168:171], v[40:43]
    v_mfma_f32_16x16x32_bf16 v[44:47], v[236:239], v[172:175], v[44:47]
    v_mfma_f32_16x16x32_bf16 v[48:51], v[240:243], v[160:163], v[48:51]
    v_mfma_f32_16x16x32_bf16 v[52:55], v[240:243], v[164:167], v[52:55]
    v_mfma_f32_16x16x32_bf16 v[56:59], v[240:243], v[168:171], v[56:59]
    v_mfma_f32_16x16x32_bf16 v[60:63], v[240:243], v[172:175], v[60:63]
    v_mfma_f32_16x16x32_bf16 v[64:67], v[244:247], v[160:163], v[64:67]
    v_mfma_f32_16x16x32_bf16 v[68:71], v[244:247], v[164:167], v[68:71]
    v_mfma_f32_16x16x32_bf16 v[72:75], v[244:247], v[168:171], v[72:75]
    v_mfma_f32_16x16x32_bf16 v[76:79], v[244:247], v[172:175], v[76:79]
    v_mfma_f32_16x16x32_bf16 v[80:83], v[248:251], v[160:163], v[80:83]
    v_mfma_f32_16x16x32_bf16 v[84:87], v[248:251], v[164:167], v[84:87]
    v_mfma_f32_16x16x32_bf16 v[88:91], v[248:251], v[168:171], v[88:91]
    v_mfma_f32_16x16x32_bf16 v[92:95], v[248:251], v[172:175], v[92:95]
    v_mfma_f32_16x16x32_bf16 v[96:99], v[252:255], v[160:163], v[96:99]
    v_mfma_f32_16x16x32_bf16 v[100:103], v[252:255], v[164:167], v[100:103]
    v_mfma_f32_16x16x32_bf16 v[104:107], v[252:255], v[168:171], v[104:107]
    v_mfma_f32_16x16x32_bf16 v[108:111], v[252:255], v[172:175], v[108:111]
    ds_read_b128 v[236:239], v3 offset:5120
    ds_read_b128 v[240:243], v3 offset:6144
    ds_read_b128 v[244:247], v3 offset:7168
    ds_read_b128 v[248:251], v3 offset:8192
    ds_read_b128 v[252:255], v3 offset:9216
    s_waitcnt vmcnt(8)
    v_mfma_f32_16x16x32_bf16 v[32:35], v[176:179], v[112:115], v[32:35]
    v_mfma_f32_16x16x32_bf16 v[36:39], v[176:179], v[116:119], v[36:39]
    v_mfma_f32_16x16x32_bf16 v[40:43], v[176:179], v[120:123], v[40:43]
    v_mfma_f32_16x16x32_bf16 v[44:47], v[176:179], v[124:127], v[44:47]
    v_mfma_f32_16x16x32_bf16 v[48:51], v[180:183], v[112:115], v[48:51]
    v_mfma_f32_16x16x32_bf16 v[52:55], v[180:183], v[116:119], v[52:55]
    v_mfma_f32_16x16x32_bf16 v[56:59], v[180:183], v[120:123], v[56:59]
    v_mfma_f32_16x16x32_bf16 v[60:63], v[180:183], v[124:127], v[60:63]
    v_mfma_f32_16x16x32_bf16 v[64:67], v[184:187], v[112:115], v[64:67]
    v_mfma_f32_16x16x32_bf16 v[68:71], v[184:187], v[116:119], v[68:71]
    v_mfma_f32_16x16x32_bf16 v[72:75], v[184:187], v[120:123], v[72:75]
    v_mfma_f32_16x16x32_bf16 v[76:79], v[184:187], v[124:127], v[76:79]
    v_mfma_f32_16x16x32_bf16 v[80:83], v[188:191], v[112:115], v[80:83]
    v_mfma_f32_16x16x32_bf16 v[84:87], v[188:191], v[116:119], v[84:87]
    v_mfma_f32_16x16x32_bf16 v[88:91], v[188:191], v[120:123], v[88:91]
    v_mfma_f32_16x16x32_bf16 v[92:95], v[188:191], v[124:127], v[92:95]
    v_mfma_f32_16x16x32_bf16 v[96:99], v[192:195], v[112:115], v[96:99]
    v_mfma_f32_16x16x32_bf16 v[100:103], v[192:195], v[116:119], v[100:103]
    v_mfma_f32_16x16x32_bf16 v[104:107], v[192:195], v[120:123], v[104:107]
    v_mfma_f32_16x16x32_bf16 v[108:111], v[192:195], v[124:127], v[108:111]
    s_waitcnt lgkmcnt(5)
    s_waitcnt vmcnt(4)
    v_mfma_f32_16x16x32_bf16 v[32:35], v[216:219], v[128:131], v[32:35]
    v_mfma_f32_16x16x32_bf16 v[36:39], v[216:219], v[132:135], v[36:39]
    v_mfma_f32_16x16x32_bf16 v[40:43], v[216:219], v[136:139], v[40:43]
    v_mfma_f32_16x16x32_bf16 v[44:47], v[216:219], v[140:143], v[44:47]
    v_mfma_f32_16x16x32_bf16 v[48:51], v[220:223], v[128:131], v[48:51]
    v_mfma_f32_16x16x32_bf16 v[52:55], v[220:223], v[132:135], v[52:55]
    v_mfma_f32_16x16x32_bf16 v[56:59], v[220:223], v[136:139], v[56:59]
    v_mfma_f32_16x16x32_bf16 v[60:63], v[220:223], v[140:143], v[60:63]
    v_mfma_f32_16x16x32_bf16 v[64:67], v[224:227], v[128:131], v[64:67]
    v_mfma_f32_16x16x32_bf16 v[68:71], v[224:227], v[132:135], v[68:71]
    v_mfma_f32_16x16x32_bf16 v[72:75], v[224:227], v[136:139], v[72:75]
    v_mfma_f32_16x16x32_bf16 v[76:79], v[224:227], v[140:143], v[76:79]
    v_mfma_f32_16x16x32_bf16 v[80:83], v[228:231], v[128:131], v[80:83]
    v_mfma_f32_16x16x32_bf16 v[84:87], v[228:231], v[132:135], v[84:87]
    v_mfma_f32_16x16x32_bf16 v[88:91], v[228:231], v[136:139], v[88:91]
    v_mfma_f32_16x16x32_bf16 v[92:95], v[228:231], v[140:143], v[92:95]
    v_mfma_f32_16x16x32_bf16 v[96:99], v[232:235], v[128:131], v[96:99]
    v_mfma_f32_16x16x32_bf16 v[100:103], v[232:235], v[132:135], v[100:103]
    v_mfma_f32_16x16x32_bf16 v[104:107], v[232:235], v[136:139], v[104:107]
    v_mfma_f32_16x16x32_bf16 v[108:111], v[232:235], v[140:143], v[108:111]
    s_waitcnt lgkmcnt(0)
    s_waitcnt vmcnt(0)
    v_swap_b32 v198, v200
    v_swap_b32 v199, v201
    v_swap_b32 v206, v208
    v_swap_b32 v207, v209
    s_nop 1
    v_mfma_f32_16x16x32_bf16 v[32:35], v[236:239], v[196:199], v[32:35]
    v_mfma_f32_16x16x32_bf16 v[36:39], v[236:239], v[204:207], v[36:39]
    v_mfma_f32_16x16x32_bf16 v[40:43], v[236:239], v[200:203], v[40:43]
    v_mfma_f32_16x16x32_bf16 v[44:47], v[236:239], v[208:211], v[44:47]
    v_mfma_f32_16x16x32_bf16 v[48:51], v[240:243], v[196:199], v[48:51]
    v_mfma_f32_16x16x32_bf16 v[52:55], v[240:243], v[204:207], v[52:55]
    v_mfma_f32_16x16x32_bf16 v[56:59], v[240:243], v[200:203], v[56:59]
    v_mfma_f32_16x16x32_bf16 v[60:63], v[240:243], v[208:211], v[60:63]
    v_mfma_f32_16x16x32_bf16 v[64:67], v[244:247], v[196:199], v[64:67]
    ds_write_b128 v4, v[32:35] offset:0
    v_mfma_f32_16x16x32_bf16 v[68:71], v[244:247], v[204:207], v[68:71]
    ds_write_b128 v4, v[36:39] offset:5376
    v_mfma_f32_16x16x32_bf16 v[72:75], v[244:247], v[200:203], v[72:75]
    ds_write_b128 v4, v[40:43] offset:10752
    v_mfma_f32_16x16x32_bf16 v[76:79], v[244:247], v[208:211], v[76:79]
    ds_write_b128 v4, v[44:47] offset:16128
    v_mfma_f32_16x16x32_bf16 v[80:83], v[248:251], v[196:199], v[80:83]
    ds_write_b128 v4, v[48:51] offset:32
    v_mfma_f32_16x16x32_bf16 v[84:87], v[248:251], v[204:207], v[84:87]
    ds_write_b128 v4, v[52:55] offset:5408
    v_mfma_f32_16x16x32_bf16 v[88:91], v[248:251], v[200:203], v[88:91]
    ds_write_b128 v4, v[56:59] offset:10784
    v_mfma_f32_16x16x32_bf16 v[92:95], v[248:251], v[208:211], v[92:95]
    ds_write_b128 v4, v[60:63] offset:16160
    v_mfma_f32_16x16x32_bf16 v[96:99], v[252:255], v[196:199], v[96:99]
    ds_write_b128 v4, v[64:67] offset:64
    v_mfma_f32_16x16x32_bf16 v[100:103], v[252:255], v[204:207], v[100:103]
    ds_write_b128 v4, v[68:71] offset:5440
    v_mfma_f32_16x16x32_bf16 v[104:107], v[252:255], v[200:203], v[104:107]
    ds_write_b128 v4, v[72:75] offset:10816
    v_mfma_f32_16x16x32_bf16 v[108:111], v[252:255], v[208:211], v[108:111]
    ds_write_b128 v4, v[76:79] offset:16192
    ds_write_b128 v4, v[80:83] offset:96
    ds_write_b128 v4, v[84:87] offset:5472
    ds_write_b128 v4, v[88:91] offset:10848
    ds_write_b128 v4, v[92:95] offset:16224
    ds_write_b128 v4, v[96:99] offset:128
    ds_write_b128 v4, v[100:103] offset:5504
    ds_write_b128 v4, v[104:107] offset:10880
    ds_write_b128 v4, v[108:111] offset:16256
    s_waitcnt lgkmcnt(0)
    s_barrier
    ds_read_b128 v[112:115], v29 offset:0
    ds_read_b128 v[116:119], v29 offset:160
    ds_read_b128 v[120:123], v29 offset:21504
    ds_read_b128 v[124:127], v29 offset:21664
    ds_read_b128 v[128:131], v29 offset:43008
    ds_read_b128 v[132:135], v29 offset:43168
    ds_read_b128 v[136:139], v29 offset:64512
    ds_read_b128 v[140:143], v29 offset:64672
    ds_read_b128 v[144:147], v30 offset:0
    ds_read_b128 v[148:151], v30 offset:160
    ds_read_b128 v[152:155], v30 offset:21504
    ds_read_b128 v[156:159], v30 offset:21664
    ds_read_b128 v[160:163], v30 offset:43008
    ds_read_b128 v[164:167], v30 offset:43168
    ds_read_b128 v[168:171], v30 offset:64512
    ds_read_b128 v[172:175], v30 offset:64672
    ds_read_b128 v[176:179], v31 offset:0
    ds_read_b128 v[180:183], v31 offset:160
    ds_read_b128 v[184:187], v31 offset:21504
    ds_read_b128 v[188:191], v31 offset:21664
    ds_read_b128 v[192:195], v31 offset:43008
    ds_read_b128 v[196:199], v31 offset:43168
    ds_read_b128 v[200:203], v31 offset:64512
    ds_read_b128 v[204:207], v31 offset:64672
    v_lshlrev_b32 v32, 16, v14
    v_and_b32 v33, 0xffff0000, v14
    v_lshlrev_b32 v34, 16, v15
    v_and_b32 v35, 0xffff0000, v15
    v_lshlrev_b32 v36, 16, v16
    v_and_b32 v37, 0xffff0000, v16
    v_lshlrev_b32 v38, 16, v17
    v_and_b32 v39, 0xffff0000, v17
    v_lshlrev_b32 v40, 16, v18
    v_and_b32 v41, 0xffff0000, v18
    v_lshlrev_b32 v42, 16, v19
    v_and_b32 v43, 0xffff0000, v19
    v_lshlrev_b32 v44, 16, v20
    v_and_b32 v45, 0xffff0000, v20
    v_lshlrev_b32 v46, 16, v21
    v_and_b32 v47, 0xffff0000, v21
    v_lshlrev_b32 v48, 16, v22
    v_and_b32 v49, 0xffff0000, v22
    v_lshlrev_b32 v50, 16, v23
    v_and_b32 v51, 0xffff0000, v23
    v_lshlrev_b32 v52, 16, v24
    v_and_b32 v53, 0xffff0000, v24
    v_lshlrev_b32 v54, 16, v25
    v_and_b32 v55, 0xffff0000, v25
    s_waitcnt lgkmcnt(15)
    v_pk_add_f32 v[112:113], v[112:113], v[120:121]
    v_pk_add_f32 v[128:129], v[128:129], v[136:137]
    v_pk_add_f32 v[114:115], v[114:115], v[122:123]
    v_pk_add_f32 v[130:131], v[130:131], v[138:139]
    v_pk_add_f32 v[116:117], v[116:117], v[124:125]
    v_pk_add_f32 v[132:133], v[132:133], v[140:141]
    v_pk_add_f32 v[118:119], v[118:119], v[126:127]
    v_pk_add_f32 v[134:135], v[134:135], v[142:143]
    v_pk_add_f32 v[112:113], v[112:113], v[32:33]
    v_pk_add_f32 v[114:115], v[114:115], v[34:35]
    v_pk_add_f32 v[116:117], v[116:117], v[36:37]
    v_pk_add_f32 v[118:119], v[118:119], v[38:39]
    v_pk_add_f32 v[112:113], v[112:113], v[128:129]
    v_pk_add_f32 v[114:115], v[114:115], v[130:131]
    v_pk_add_f32 v[116:117], v[116:117], v[132:133]
    v_pk_add_f32 v[118:119], v[118:119], v[134:135]
    v_cvt_pk_bf16_f32 v120, v112, v113
    v_cvt_pk_bf16_f32 v121, v114, v115
    v_cvt_pk_bf16_f32 v122, v116, v117
    v_cvt_pk_bf16_f32 v123, v118, v119
    buffer_store_dwordx4 v[120:123], v26, s[20:23], s40 offen
    s_waitcnt lgkmcnt(8)
    v_pk_add_f32 v[144:145], v[144:145], v[152:153]
    v_pk_add_f32 v[160:161], v[160:161], v[168:169]
    v_pk_add_f32 v[146:147], v[146:147], v[154:155]
    v_pk_add_f32 v[162:163], v[162:163], v[170:171]
    v_pk_add_f32 v[148:149], v[148:149], v[156:157]
    v_pk_add_f32 v[164:165], v[164:165], v[172:173]
    v_pk_add_f32 v[150:151], v[150:151], v[158:159]
    v_pk_add_f32 v[166:167], v[166:167], v[174:175]
    v_pk_add_f32 v[144:145], v[144:145], v[40:41]
    v_pk_add_f32 v[146:147], v[146:147], v[42:43]
    v_pk_add_f32 v[148:149], v[148:149], v[44:45]
    v_pk_add_f32 v[150:151], v[150:151], v[46:47]
    v_pk_add_f32 v[144:145], v[144:145], v[160:161]
    v_pk_add_f32 v[146:147], v[146:147], v[162:163]
    v_pk_add_f32 v[148:149], v[148:149], v[164:165]
    v_pk_add_f32 v[150:151], v[150:151], v[166:167]
    v_cvt_pk_bf16_f32 v152, v144, v145
    v_cvt_pk_bf16_f32 v153, v146, v147
    v_cvt_pk_bf16_f32 v154, v148, v149
    v_cvt_pk_bf16_f32 v155, v150, v151
    buffer_store_dwordx4 v[152:155], v27, s[20:23], s40 offen
    s_waitcnt lgkmcnt(0)
    v_pk_add_f32 v[176:177], v[176:177], v[184:185]
    v_pk_add_f32 v[192:193], v[192:193], v[200:201]
    v_pk_add_f32 v[178:179], v[178:179], v[186:187]
    v_pk_add_f32 v[194:195], v[194:195], v[202:203]
    v_pk_add_f32 v[180:181], v[180:181], v[188:189]
    v_pk_add_f32 v[196:197], v[196:197], v[204:205]
    v_pk_add_f32 v[182:183], v[182:183], v[190:191]
    v_pk_add_f32 v[198:199], v[198:199], v[206:207]
    v_pk_add_f32 v[176:177], v[176:177], v[48:49]
    v_pk_add_f32 v[178:179], v[178:179], v[50:51]
    v_pk_add_f32 v[180:181], v[180:181], v[52:53]
    v_pk_add_f32 v[182:183], v[182:183], v[54:55]
    v_pk_add_f32 v[176:177], v[176:177], v[192:193]
    v_pk_add_f32 v[178:179], v[178:179], v[194:195]
    v_pk_add_f32 v[180:181], v[180:181], v[196:197]
    v_pk_add_f32 v[182:183], v[182:183], v[198:199]
    v_cvt_pk_bf16_f32 v184, v176, v177
    v_cvt_pk_bf16_f32 v185, v178, v179
    v_cvt_pk_bf16_f32 v186, v180, v181
    v_cvt_pk_bf16_f32 v187, v182, v183
    buffer_store_dwordx4 v[184:187], v28, s[20:23], s40 offen
    s_endpgm
K2G_wq:
    v_lshlrev_b32 v11, 2, v2
    s_mul_i32 s15, s49, 5
    s_lshr_b32 s15, s15, 1
    s_lshl_b32 s15, s15, 8
    s_add_u32 s71, s15, 27209728
    buffer_load_dword v196, v11, s[24:27], s71 offen offset:0 sc1
    buffer_load_dword v197, v11, s[24:27], s71 offen offset:256 sc1
    buffer_load_dword v198, v11, s[24:27], s71 offen offset:512 sc1
    s_branch K2G_next
K2G_wt:
    v_and_b32 v10, 1, v5
    v_lshlrev_b32 v10, 9, v10
    v_lshrrev_b32 v11, 1, v5
    v_lshl_add_u32 v10, v11, 3, v10
    v_lshl_add_u32 v10, v6, 4, v10
    s_lshl_b32 s60, s48, 1
    s_add_u32 s60, s60, s56
    s_mul_i32 s15, s60, 48
    s_mul_i32 s59, s70, 3
    s_add_u32 s15, s15, s59
    s_add_u32 s58, s15, s57
    s_lshl_b32 s58, s58, 10
    s_add_u32 s58, s58, 8388608
    s_sub_u32 s59, s15, s57
    s_sub_u32 s59, s59, s57
    s_lshl_b32 s59, s59, 10
    s_add_u32 s59, s59, 8390656
    buffer_load_dwordx2 v[20:21], v10, s[24:27], s58 offen offset:0 sc1
    buffer_load_dwordx2 v[26:27], v10, s[24:27], s58 offen offset:256 sc1
    buffer_load_dwordx2 v[22:23], v10, s[24:27], s58 offen offset:1024 sc1
    buffer_load_dwordx2 v[28:29], v10, s[24:27], s58 offen offset:1280 sc1
    buffer_load_dwordx2 v[24:25], v10, s[24:27], s59 offen offset:0 sc1
    buffer_load_dwordx2 v[30:31], v10, s[24:27], s59 offen offset:256 sc1
    v_lshlrev_b32 v10, 1, v6
    s_lshl_b32 s59, s60, 6
    buffer_load_ushort v32, v10, s[20:23], s59 offen offset:0
    buffer_load_ushort v33, v10, s[20:23], s59 offen offset:32
    v_xor_b32 v196, s3, v196
    v_xor_b32 v197, s3, v197
    v_xor_b32 v198, s3, v198
    v_or3_b32 v196, v196, v197, v198
    v_cmp_ne_u32 vcc, 0, v196
    s_and_b32 vcc_hi, vcc_hi, 0xfff
    s_cmp_eq_u64 vcc, 0
    s_cbranch_scc0 K2G_next
    s_mov_b32 s73, 1
    s_and_b32 s15, s48, 7
    s_lshl_b32 s15, s15, 2
    s_add_u32 s15, s15, s12
    s_mul_i32 s15, s15, 7040
    s_mul_i32 s71, s49, 220
    s_lshl_b32 s71, s71, 10
    s_add_u32 s71, s71, s15
    s_add_u32 s71, s71, 25165824
    v_min_u32 v11, 54, v2
    v_lshlrev_b32 v11, 7, v11
    buffer_load_dword v196, v11, s[24:27], s71 offen sc1
    s_branch K2G_next
K2_exit:
    s_endpgm
CODE_END:
    s_endpgm
.section .rodata,"a"
.p2align 6
.amdhsa_kernel parallel_sum__softmax_full_mha__mixer_gmlp__prompt_kernel
  .amdhsa_next_free_vgpr 256
  .amdhsa_next_free_sgpr 102
  .amdhsa_accum_offset 256
  .amdhsa_group_segment_fixed_size 0
  .amdhsa_kernarg_size 88
  .amdhsa_user_sgpr_count 2
  .amdhsa_user_sgpr_kernarg_segment_ptr 1
  .amdhsa_system_sgpr_workgroup_id_x 1
.end_amdhsa_kernel
```
